```python
import torch

def _softmax(x, axis=-1):
    return torch.softmax(x, dim=axis)
def _gelu(x):
    return torch.nn.functional.gelu(x, approximate="tanh")
def _silu(x):
    return torch.nn.functional.silu(x)
def _sigmoid(x):
    return torch.sigmoid(x)
def _layernorm(x, axis=-1, eps=1e-5):
    m = x.mean(dim=axis, keepdim=True)
    v = x.var(dim=axis, keepdim=True, unbiased=False)
    return (x - m) / torch.sqrt(v + eps)
def _scatter_add(tgt, idx, src, axis=0):
    return tgt.clone().index_add_(axis, idx, src)
def _segment_sum(src, seg, n):
    out = torch.zeros((n,) + src.shape[1:], dtype=src.dtype)
    return out.index_add_(0, seg, src)
def _pad(x, pw):
    flat = tuple(v for pair in reversed(pw) for v in pair)
    return torch.nn.functional.pad(x, flat)

kernel_name = 'gated_mix__sliding_block_cached__glu_gated_swiglu__decode'

def setup_inputs():

    _w = (lambda a: (lambda t: t.to(torch.bfloat16) if t.is_floating_point() else t)(torch.as_tensor(a)))
    def _A_setup():
        B, Sq, D = 8, 1, 640
        Hq, Hkv, Sk, Dh = 32, 32, 4096, 128
        assert Hq % Hkv == 0, (Hq, Hkv)
        return {
            "x": _w((lambda *s: torch.randn(*s, dtype=torch.bfloat16) * 0.05)(B, Sq, D)),
            "k_cache": _w((lambda *s: torch.randn(*s, dtype=torch.bfloat16) * 6.4)(B, Hkv, Sk, Dh)),
            "v_cache": _w((lambda *s: torch.randn(*s, dtype=torch.bfloat16) * 0.05)(B, Hkv, Sk, Dh)),
            "wq": _w((lambda *s: torch.randn(*s, dtype=torch.bfloat16) * 6.4)(D, Hq * Dh) * (D ** -0.5)),
            "wo": _w((lambda *s: torch.randn(*s, dtype=torch.bfloat16) * 0.05)(Hq * Dh, D) * ((Hq * Dh) ** -0.5)),
        }
    _A_in = _A_setup()

    def _B_setup():
        B, S, D, F = 8, 1, 640, 1728
        return {
            "x": _w((lambda *s: torch.randn(*s, dtype=torch.bfloat16) * 0.05)(B, S, D)),
            "w1": _w((lambda *s: torch.randn(*s, dtype=torch.bfloat16) * 0.4)(D, F) * (2.0 / D) ** 0.5),
            "w3": _w((lambda *s: torch.randn(*s, dtype=torch.bfloat16) * 0.4)(D, F) * (2.0 / D) ** 0.5),
            "w2": _w((lambda *s: torch.randn(*s, dtype=torch.bfloat16) * 0.4)(F, D) * (2.0 / F) ** 0.5),
        }
    _B_in = _B_setup()

    return {
        "A_x": _A_in["x"],
        "A_k_cache": _A_in["k_cache"],
        "A_v_cache": _A_in["v_cache"],
        "A_wq": _A_in["wq"],
        "A_wo": _A_in["wo"],
        "B_x": _B_in["x"],
        "B_w1": _B_in["w1"],
        "B_w3": _B_in["w3"],
        "B_w2": _B_in["w2"],
        "gate_w": _w((lambda *s: torch.randn(*s, dtype=torch.bfloat16) * 0.05)(640) * 16.0),
    }

def reference(A_x, A_k_cache, A_v_cache, A_wq, A_wo, B_x, B_w1, B_w3, B_w2, gate_w):
    def _A_ref(x, k_cache, v_cache, wq, wo):
        B, Sq, D = x.shape
        Hq, Dh = 32, 128
        Hkv, Sk = k_cache.shape[1], k_cache.shape[2]
        W = min(4096, max(256, Sk // 4))
        rep = Hq // Hkv
        q = (lambda x, *d: x.permute(*d))((x @ wq).reshape(B, Sq, Hq, Dh), 0, 2, 1, 3)
        k = (lambda x, n, axis: torch.repeat_interleave(x, n, dim=axis))(k_cache[:, :, Sk - W:, :], rep, axis=1)
        v = (lambda x, n, axis: torch.repeat_interleave(x, n, dim=axis))(v_cache[:, :, Sk - W:, :], rep, axis=1)
        scores = torch.einsum("bhqd,bhkd->bhqk", q, k) * (Dh ** -0.5)
        p = _softmax(scores, axis=-1)
        o = torch.einsum("bhqk,bhkd->bhqd", p, v)
        return (lambda x, *d: x.permute(*d))(o, 0, 2, 1, 3).reshape(B, Sq, Hq * Dh) @ wo

    def _B_ref(x, w1, w3, w2):
        gate = torch.einsum("bsd,df->bsf", x, w1)
        up = torch.einsum("bsd,df->bsf", x, w3)
        h = _silu(gate) * up
        out = torch.einsum("bsf,fd->bsd", h, w2)
        return out

    x = A_x
    g = _sigmoid((x * gate_w).sum(-1, keepdims=True))
    a = _A_ref(x, A_k_cache, A_v_cache, A_wq, A_wo)
    b = _B_ref(x, B_w1, B_w3, B_w2)
    return g * a + (1 - g) * b
```

```asm
; @launch grid=(256,1,1) block=(512,1,1) lds=163840
.amdgcn_target "amdgcn-amd-amdhsa--gfx950"
.text
.globl gated_mix__sliding_block_cached__glu_gated_swiglu__decode_kernel
.p2align 8
.type gated_mix__sliding_block_cached__glu_gated_swiglu__decode_kernel,@function
gated_mix__sliding_block_cached__glu_gated_swiglu__decode_kernel:
    s_cmp_ge_u32 s2, 256
    s_cbranch_scc1 L_end
    s_load_dwordx16 s[16:31], s[0:1], 0
    s_load_dwordx8 s[32:39], s[0:1], 64
    s_load_dwordx2 s[40:41], s[0:1], 96
    v_lshrrev_b32 v9, 6, v0
    v_and_b32 v0, 63, v0
    v_readfirstlane_b32 s3, v9
    s_and_b32 s4, s2, 7
    s_lshl_b32 s4, s4, 2
    s_bfe_u32 s5, s2, 0x20003
    s_add_u32 s4, s4, s5
    s_lshr_b32 s5, s2, 5
    s_lshl_b32 s6, s5, 5
    s_add_u32 s6, s6, s4
    s_movk_i32 s10, 8192
    s_sub_u32 s93, s4, 5
    s_cselect_b32 s93, 31, s93
    v_lshlrev_b32 v47, 4, v0
    s_lshl_b32 s64, s3, 10
    v_add_u32 v1, s64, v47
    s_lshl_b32 s67, s93, 7
    s_lshl_b32 s68, s4, 8
    s_bfe_u32 s69, s5, 0x10001
    s_lshl_b32 s69, s69, 7
    s_add_u32 s68, s68, s69
    s_movk_i32 s66, 3456
    s_cmp_lt_u32 s5, 4
    s_cselect_b32 s66, s10, s66
    s_cselect_b32 s67, s68, s67
    s_and_b32 s68, s5, 1
    s_mul_i32 s65, s68, 320
    s_mul_i32 s69, s3, 40
    s_add_u32 s69, s69, s65
    v_lshrrev_b32 v10, 3, v0
    v_add_u32 v10, s69, v10
    v_mul_u32_u24 v10, s66, v10
    v_and_b32 v11, 0x70, v47
    v_add3_u32 v10, v10, v11, s67
    s_lshl_b32 s66, s66, 3
    v_and_b32 v9, 7, v0
    v_mul_u32_u24 v9, 1280, v9
    v_and_b32 v11, 48, v0
    s_lshl_b32 s65, s65, 1
    v_add3_u32 v44, v9, v11, s65
    s_lshl_b32 s7, s6, 20
    s_add_u32 s7, s7, 0xC0000
    s_cmp_lt_u32 s93, 27
    s_cselect_b32 s68, 2211840, 0
    s_mul_i32 s71, s3, 5120
    s_add_u32 s71, s71, 24576
    s_waitcnt lgkmcnt(0)
    s_cmp_lt_u32 s5, 6
    s_cselect_b64 s[52:53], s[28:29], s[30:31]
    s_cmp_lt_u32 s5, 4
    s_cselect_b64 s[52:53], s[22:23], s[52:53]
    s_cselect_b32 s54, 5242880, s68
    s_mov_b32 s55, 0x20000
    s_mov_b32 m0, s71
    s_load_dword s88, s[40:41], 0
    buffer_load_dwordx4 v10, s[52:55], 0 offen nt lds
    s_mov_b32 s70, s66
    s_add_u32 s44, s18, s7
    s_addc_u32 s45, s19, 0
    s_mov_b32 s46, 0x40000
    s_mov_b32 s47, 0x20000
    s_add_u32 m0, s71, 1024
    s_nop 0
    buffer_load_dwordx4 v10, s[52:55], s70 offen nt lds
    s_add_u32 m0, s71, 2048
    s_add_u32 s70, s70, s66
    buffer_load_dwordx4 v10, s[52:55], s70 offen nt lds
    s_add_u32 m0, s71, 3072
    s_add_u32 s70, s70, s66
    buffer_load_dwordx4 v10, s[52:55], s70 offen nt lds
    s_add_u32 m0, s71, 4096
    s_add_u32 s70, s70, s66
    buffer_load_dwordx4 v10, s[52:55], s70 offen nt lds
    buffer_load_dwordx4 v[48:51], v1, s[44:47], 0 offen nt
    s_mov_b32 s8, s10
    buffer_load_dwordx4 v[52:55], v1, s[44:47], s8 offen nt
    s_mov_b32 s72, s16
    s_mov_b32 s73, s17
    s_mov_b32 s74, 10240
    s_mov_b32 s75, 0x20000
    s_cmp_ge_u32 s3, 4
    s_cbranch_scc1 L_nox
    s_add_u32 s76, s16, 8192
    s_addc_u32 s77, s17, 0
    s_movk_i32 s78, 1280
    s_cmp_lt_u32 s3, 2
    s_cselect_b64 s[76:77], s[76:77], s[34:35]
    s_cselect_b32 s78, 2048, s78
    s_mov_b32 s79, 0x20000
    v_and_b32 v9, 0x7ff, v1
    s_add_u32 m0, s64, 12288
    s_nop 0
    buffer_load_dwordx4 v9, s[76:79], 0 offen lds
L_nox:
    s_add_u32 m0, s64, 4096
    s_nop 0
    buffer_load_dwordx4 v1, s[72:75], 0 offen lds
    s_add_u32 s8, s8, s10
    buffer_load_dwordx4 v[56:59], v1, s[44:47], s8 offen nt
    s_add_u32 s8, s8, s10
    buffer_load_dwordx4 v[60:63], v1, s[44:47], s8 offen nt
    s_add_u32 s48, s20, s7
    s_addc_u32 s49, s21, 0
    s_mov_b32 s50, 0x40000
    s_mov_b32 s51, 0x20000
    s_mul_i32 s7, s4, 163840
    s_add_u32 s56, s24, s7
    s_addc_u32 s57, s25, 0
    s_mov_b32 s58, 163840
    s_mov_b32 s59, 0x20000
    s_mov_b32 s60, s32
    s_mov_b32 s61, s33
    s_mov_b32 s62, 2211840
    s_mov_b32 s63, 0x20000
    s_mov_b32 s80, s36
    s_mov_b32 s81, s37
    s_mov_b32 s82, 10240
    s_mov_b32 s83, 0x20000
    s_mov_b32 s84, s40
    s_mov_b32 s85, s41
    s_mov_b32 s86, 1183744
    s_mov_b32 s87, 0x20000
    v_lshrrev_b32 v11, 4, v0
    s_and_b32 s7, s3, 2
    s_lshl_b32 s7, s7, 6
    v_lshl_add_u32 v9, v11, 5, s7
    v_and_b32 v10, 0xf0, v47
    v_xor_b32 v9, v9, v10
    s_mul_i32 s7, s3, 5120
    v_mul_u32_u24 v2, 1280, v11
    v_add3_u32 v2, v2, s7, v9
    v_and_b32 v9, 1, v0
    v_lshlrev_b32 v9, 4, v9
    v_mov_b32 v46, 0xffff
    v_lshlrev_b32 v46, v9, v46
    v_bfe_u32 v9, v0, 1, 2
    v_cmp_eq_u32 vcc, 0, v9
    s_nop 1
    v_cndmask_b32 v5, 0, v46, vcc
    v_cmp_eq_u32 vcc, 1, v9
    s_nop 1
    v_cndmask_b32 v6, 0, v46, vcc
    v_cmp_eq_u32 vcc, 2, v9
    s_nop 1
    v_cndmask_b32 v7, 0, v46, vcc
    v_cmp_eq_u32 vcc, 3, v9
    s_nop 1
    v_cndmask_b32 v8, 0, v46, vcc
    s_lshl_b32 s7, s93, 3
    s_add_u32 s7, s7, s3
    s_mul_i32 s18, s7, 10240
    v_mul_u32_u24 v4, 2560, v11
    v_add3_u32 v4, v4, s18, v10
    v_bfe_u32 v9, v0, 2, 2
    v_lshl_add_u32 v45, v11, 3, v9
    v_and_b32 v10, 3, v0
    v_lshlrev_b32 v10, 3, v10
    v_bfe_u32 v9, v0, 2, 3
    v_lshlrev_b32 v9, 5, v9
    s_lshl_b32 s18, s3, 5
    v_xor_b32 v9, s18, v9
    v_lshlrev_b32 v3, 8, v45
    v_add3_u32 v3, v3, v9, v10
    s_lshl_b32 s18, s3, 6
    s_add_u32 s18, s18, 24576
    v_lshlrev_b32 v45, 7, v45
    v_add3_u32 v45, v45, s18, v10
    s_add_u32 m0, s64, 65536
    s_mov_b32 s15, 0
    buffer_load_dwordx4 v2, s[56:59], s15 offen  lds
    s_add_u32 s8, s8, s10
    buffer_load_dwordx4 v[64:67], v1, s[44:47], s8 offen nt
    s_add_u32 s8, s8, s10
    buffer_load_dwordx4 v[68:71], v1, s[44:47], s8 offen nt
    s_add_u32 m0, s64, 73728
    s_mov_b32 s15, 40960
    buffer_load_dwordx4 v2, s[56:59], s15 offen  lds
    s_waitcnt vmcnt(7)
    s_add_u32 s8, s8, s10
    buffer_load_dwordx4 v[72:75], v1, s[44:47], s8 offen nt
    s_waitcnt vmcnt(7)
    s_add_u32 s8, s8, s10
    buffer_load_dwordx4 v[76:79], v1, s[44:47], s8 offen nt
    s_waitcnt lgkmcnt(0)
    s_add_u32 s88, s88, 0x1d130b05
    s_mov_b32 s92, s88
    s_bfe_u32 s89, s88, 0x80008
    s_bfe_u32 s90, s88, 0x80010
    s_bfe_u32 s91, s88, 0x80018
    s_and_b32 s88, s88, 0xff
    v_mov_b32 v46, 0xff
    s_barrier
    s_add_u32 m0, s64, 81920
    s_mov_b32 s15, 81920
    buffer_load_dwordx4 v2, s[56:59], s15 offen  lds
    s_add_u32 s8, s8, s10
    buffer_load_dwordx4 v[80:83], v1, s[44:47], s8 offen nt
    s_cmp_ge_u32 s3, 2
    s_cbranch_scc1 L_nofront
    ds_read_b128 v[108:111], v44 offset:4096
    ds_read_b64_tr_b16 v[92:93], v45 offset:0
    ds_read_b64_tr_b16 v[94:95], v45 offset:512
    ds_read_b64_tr_b16 v[96:97], v45 offset:32
    ds_read_b64_tr_b16 v[98:99], v45 offset:544
    ds_read_b128 v[112:115], v44 offset:4160
    ds_read_b64_tr_b16 v[100:101], v45 offset:4096
    ds_read_b64_tr_b16 v[102:103], v45 offset:4608
    ds_read_b64_tr_b16 v[104:105], v45 offset:4128
    ds_read_b64_tr_b16 v[106:107], v45 offset:4640
    s_waitcnt lgkmcnt(5)
    v_mfma_f32_16x16x32_bf16 v[84:87], v[92:95], v[108:111], 0
    v_mfma_f32_16x16x32_bf16 v[88:91], v[96:99], v[108:111], 0
    s_nop 3
    ds_read_b128 v[108:111], v44 offset:4224
    ds_read_b64_tr_b16 v[92:93], v45 offset:8192
    ds_read_b64_tr_b16 v[94:95], v45 offset:8704
    ds_read_b64_tr_b16 v[96:97], v45 offset:8224
    ds_read_b64_tr_b16 v[98:99], v45 offset:8736
    s_waitcnt lgkmcnt(5)
    v_mfma_f32_16x16x32_bf16 v[84:87], v[100:103], v[112:115], v[84:87]
    v_mfma_f32_16x16x32_bf16 v[88:91], v[104:107], v[112:115], v[88:91]
    s_nop 3
    ds_read_b128 v[112:115], v44 offset:4288
    ds_read_b64_tr_b16 v[100:101], v45 offset:12288
    ds_read_b64_tr_b16 v[102:103], v45 offset:12800
    ds_read_b64_tr_b16 v[104:105], v45 offset:12320
    ds_read_b64_tr_b16 v[106:107], v45 offset:12832
    s_waitcnt lgkmcnt(5)
    v_mfma_f32_16x16x32_bf16 v[84:87], v[92:95], v[108:111], v[84:87]
    v_mfma_f32_16x16x32_bf16 v[88:91], v[96:99], v[108:111], v[88:91]
    s_nop 3
    ds_read_b128 v[108:111], v44 offset:4352
    ds_read_b64_tr_b16 v[92:93], v45 offset:16384
    ds_read_b64_tr_b16 v[94:95], v45 offset:16896
    ds_read_b64_tr_b16 v[96:97], v45 offset:16416
    ds_read_b64_tr_b16 v[98:99], v45 offset:16928
    s_waitcnt lgkmcnt(5)
    v_mfma_f32_16x16x32_bf16 v[84:87], v[100:103], v[112:115], v[84:87]
    v_mfma_f32_16x16x32_bf16 v[88:91], v[104:107], v[112:115], v[88:91]
    s_nop 3
    ds_read_b128 v[112:115], v44 offset:4416
    ds_read_b64_tr_b16 v[100:101], v45 offset:20480
    ds_read_b64_tr_b16 v[102:103], v45 offset:20992
    ds_read_b64_tr_b16 v[104:105], v45 offset:20512
    ds_read_b64_tr_b16 v[106:107], v45 offset:21024
    s_waitcnt lgkmcnt(5)
    v_mfma_f32_16x16x32_bf16 v[84:87], v[92:95], v[108:111], v[84:87]
    v_mfma_f32_16x16x32_bf16 v[88:91], v[96:99], v[108:111], v[88:91]
    s_nop 3
    ds_read_b128 v[108:111], v44 offset:4480
    ds_read_b64_tr_b16 v[92:93], v45 offset:24576
    ds_read_b64_tr_b16 v[94:95], v45 offset:25088
    ds_read_b64_tr_b16 v[96:97], v45 offset:24608
    ds_read_b64_tr_b16 v[98:99], v45 offset:25120
    s_waitcnt lgkmcnt(5)
    v_mfma_f32_16x16x32_bf16 v[84:87], v[100:103], v[112:115], v[84:87]
    v_mfma_f32_16x16x32_bf16 v[88:91], v[104:107], v[112:115], v[88:91]
    s_nop 3
    ds_read_b128 v[112:115], v44 offset:4544
    ds_read_b64_tr_b16 v[100:101], v45 offset:28672
    ds_read_b64_tr_b16 v[102:103], v45 offset:29184
    ds_read_b64_tr_b16 v[104:105], v45 offset:28704
    ds_read_b64_tr_b16 v[106:107], v45 offset:29216
    s_waitcnt lgkmcnt(5)
    v_mfma_f32_16x16x32_bf16 v[84:87], v[92:95], v[108:111], v[84:87]
    v_mfma_f32_16x16x32_bf16 v[88:91], v[96:99], v[108:111], v[88:91]
    s_nop 3
    ds_read_b128 v[108:111], v44 offset:4608
    ds_read_b64_tr_b16 v[92:93], v45 offset:32768
    ds_read_b64_tr_b16 v[94:95], v45 offset:33280
    ds_read_b64_tr_b16 v[96:97], v45 offset:32800
    ds_read_b64_tr_b16 v[98:99], v45 offset:33312
    s_waitcnt lgkmcnt(5)
    v_mfma_f32_16x16x32_bf16 v[84:87], v[100:103], v[112:115], v[84:87]
    v_mfma_f32_16x16x32_bf16 v[88:91], v[104:107], v[112:115], v[88:91]
    s_nop 3
    ds_read_b128 v[112:115], v44 offset:4672
    ds_read_b64_tr_b16 v[100:101], v45 offset:36864
    ds_read_b64_tr_b16 v[102:103], v45 offset:37376
    ds_read_b64_tr_b16 v[104:105], v45 offset:36896
    ds_read_b64_tr_b16 v[106:107], v45 offset:37408
    s_waitcnt lgkmcnt(5)
    v_mfma_f32_16x16x32_bf16 v[84:87], v[92:95], v[108:111], v[84:87]
    v_mfma_f32_16x16x32_bf16 v[88:91], v[96:99], v[108:111], v[88:91]
    s_waitcnt lgkmcnt(0)
    v_mfma_f32_16x16x32_bf16 v[84:87], v[100:103], v[112:115], v[84:87]
    v_mfma_f32_16x16x32_bf16 v[88:91], v[104:107], v[112:115], v[88:91]
    s_lshl_b32 s18, s4, 14
    s_lshl_b32 s19, s5, 8
    s_add_u32 s18, s18, s19
    s_lshl_b32 s19, s3, 7
    s_add_u32 s18, s18, s19
    s_add_u32 s18, s18, 4096
    v_and_b32 v9, 7, v0
    v_lshlrev_b32 v9, 11, v9
    v_and_b32 v10, 8, v0
    v_lshl_add_u32 v9, v10, 3, v9
    v_and_b32 v10, 48, v0
    v_add_u32 v9, v9, v10
    v_mov_b32_dpp v84, v88 quad_perm:[0,1,2,3] row_mask:0xf bank_mask:0xc
    v_mov_b32_dpp v85, v89 quad_perm:[0,1,2,3] row_mask:0xf bank_mask:0xc
    v_mov_b32_dpp v86, v90 quad_perm:[0,1,2,3] row_mask:0xf bank_mask:0xc
    v_mov_b32_dpp v87, v91 quad_perm:[0,1,2,3] row_mask:0xf bank_mask:0xc
    v_add_u32 v84, 0x80, v84
    v_add_u32 v85, 0x80, v85
    v_add_u32 v86, 0x80, v86
    v_add_u32 v87, 0x80, v87
    v_bfi_b32 v84, v46, s88, v84
    v_bfi_b32 v85, v46, s89, v85
    v_bfi_b32 v86, v46, s90, v86
    v_bfi_b32 v87, v46, s91, v87
    buffer_store_dwordx4 v[84:87], v9, s[84:87], s18 offen sc1
    s_nop 1
L_nofront:
    s_waitcnt vmcnt(7)
    s_add_u32 s8, s8, s10
    buffer_load_dwordx4 v[116:119], v1, s[44:47], s8 offen nt
    s_waitcnt vmcnt(7)
    s_add_u32 m0, s64, 90112
    s_mov_b32 s15, 122880
    buffer_load_dwordx4 v2, s[56:59], s15 offen  lds
    s_waitcnt vmcnt(7)
    s_add_u32 s8, s8, s10
    buffer_load_dwordx4 v[120:123], v1, s[44:47], s8 offen nt
    s_waitcnt vmcnt(7)
    s_add_u32 s8, s8, s10
    buffer_load_dwordx4 v[124:127], v1, s[44:47], s8 offen nt
    v_lshlrev_b32 v9, 2, v0
    s_mul_i32 s18, s5, 1280
    v_add_u32 v10, s18, v9
    ds_read_b32 v128, v10 offset:4096
    ds_read_b32 v129, v10 offset:4352
    ds_read_b32 v130, v10 offset:4608
    ds_read_b32 v131, v10 offset:4864
    ds_read_b32 v132, v10 offset:5120
    ds_read_b32 v136, v9 offset:14336
    ds_read_b32 v137, v9 offset:14592
    ds_read_b32 v138, v9 offset:14848
    ds_read_b32 v139, v9 offset:15104
    ds_read_b32 v140, v9 offset:15360
    s_mov_b32 s18, 0xffff0000
    s_waitcnt lgkmcnt(0)
    v_lshlrev_b32 v133, 16, v128
    v_and_b32 v134, s18, v128
    v_lshlrev_b32 v141, 16, v136
    v_and_b32 v142, s18, v136
    v_mul_f32 v133, v133, v141
    v_mul_f32 v134, v134, v142
    v_cvt_pk_bf16_f32 v133, v133, v134
    v_lshlrev_b32 v134, 16, v133
    v_and_b32 v133, s18, v133
    v_add_f32 v135, v133, v134
    v_lshlrev_b32 v133, 16, v129
    v_and_b32 v134, s18, v129
    v_lshlrev_b32 v141, 16, v137
    v_and_b32 v142, s18, v137
    v_mul_f32 v133, v133, v141
    v_mul_f32 v134, v134, v142
    v_cvt_pk_bf16_f32 v133, v133, v134
    v_lshlrev_b32 v134, 16, v133
    v_and_b32 v133, s18, v133
    v_add_f32 v135, v135, v134
    v_add_f32 v135, v135, v133
    v_lshlrev_b32 v133, 16, v130
    v_and_b32 v134, s18, v130
    v_lshlrev_b32 v141, 16, v138
    v_and_b32 v142, s18, v138
    v_mul_f32 v133, v133, v141
    v_mul_f32 v134, v134, v142
    v_cvt_pk_bf16_f32 v133, v133, v134
    v_lshlrev_b32 v134, 16, v133
    v_and_b32 v133, s18, v133
    v_add_f32 v135, v135, v134
    v_add_f32 v135, v135, v133
    v_lshlrev_b32 v133, 16, v131
    v_and_b32 v134, s18, v131
    v_lshlrev_b32 v141, 16, v139
    v_and_b32 v142, s18, v139
    v_mul_f32 v133, v133, v141
    v_mul_f32 v134, v134, v142
    v_cvt_pk_bf16_f32 v133, v133, v134
    v_lshlrev_b32 v134, 16, v133
    v_and_b32 v133, s18, v133
    v_add_f32 v135, v135, v134
    v_add_f32 v135, v135, v133
    v_lshlrev_b32 v133, 16, v132
    v_and_b32 v134, s18, v132
    v_lshlrev_b32 v141, 16, v140
    v_and_b32 v142, s18, v140
    v_mul_f32 v133, v133, v141
    v_mul_f32 v134, v134, v142
    v_cvt_pk_bf16_f32 v133, v133, v134
    v_lshlrev_b32 v134, 16, v133
    v_and_b32 v133, s18, v133
    v_add_f32 v135, v135, v134
    v_add_f32 v135, v135, v133
    s_nop 1
    v_add_f32_dpp v135, v135, v135 row_ror:1 row_mask:0xf bank_mask:0xf
    s_nop 1
    v_add_f32_dpp v135, v135, v135 row_ror:2 row_mask:0xf bank_mask:0xf
    s_nop 1
    v_add_f32_dpp v135, v135, v135 row_ror:4 row_mask:0xf bank_mask:0xf
    s_nop 1
    v_add_f32_dpp v135, v135, v135 row_ror:8 row_mask:0xf bank_mask:0xf
    s_nop 0
    v_readlane_b32 s18, v135, 0
    v_readlane_b32 s19, v135, 16
    v_readlane_b32 s20, v135, 32
    v_readlane_b32 s21, v135, 48
    v_mov_b32 v133, s18
    v_add_f32 v133, s19, v133
    v_mov_b32 v134, s20
    v_add_f32 v134, s21, v134
    v_add_f32 v133, v133, v134
    v_cvt_pk_bf16_f32 v133, v133, v133
    v_lshlrev_b32 v133, 16, v133
    v_mul_f32 v133, 0xbfb8aa3b, v133
    v_exp_f32 v133, v133
    s_nop 0
    v_add_f32 v133, 1.0, v133
    v_rcp_f32 v133, v133
    s_nop 0
    v_cvt_pk_bf16_f32 v133, v133, v133
    v_lshlrev_b32 v133, 16, v133
    v_sub_f32 v134, 1.0, v133
    v_cvt_pk_bf16_f32 v134, v134, v134
    v_lshlrev_b32 v134, 16, v134
    v_readfirstlane_b32 s42, v133
    v_readfirstlane_b32 s43, v134
    s_waitcnt vmcnt(7)
    buffer_load_dwordx4 v[144:147], v4, s[60:63], 0 offen offset:0
    s_waitcnt vmcnt(7)
    s_add_u32 s8, s8, s10
    buffer_load_dwordx4 v[148:151], v1, s[44:47], s8 offen nt
    s_waitcnt vmcnt(7)
    buffer_load_dwordx4 v[152:155], v4, s[60:63], 0 offen offset:256
    s_waitcnt vmcnt(7)
    s_add_u32 s8, s8, s10
    buffer_load_dwordx4 v[156:159], v1, s[44:47], s8 offen nt
    s_waitcnt vmcnt(7)
    s_add_u32 s8, s8, s10
    buffer_load_dwordx4 v[160:163], v1, s[44:47], s8 offen nt
    s_waitcnt vmcnt(7)
    buffer_load_dwordx4 v[164:167], v4, s[60:63], 0 offen offset:512
    s_waitcnt vmcnt(7)
    s_add_u32 s8, s8, s10
    buffer_load_dwordx4 v[168:171], v1, s[44:47], s8 offen nt
    s_waitcnt vmcnt(7)
    s_add_u32 s8, s8, s10
    buffer_load_dwordx4 v[172:175], v1, s[44:47], s8 offen nt
    s_waitcnt vmcnt(7)
    buffer_load_dwordx4 v[176:179], v4, s[60:63], 0 offen offset:768
    s_waitcnt vmcnt(7)
    s_add_u32 s8, s8, s10
    buffer_load_dwordx4 v[180:183], v1, s[44:47], s8 offen nt
    s_and_b32 s21, s3, 1
    s_lshl_b32 s21, s21, 10
    s_lshl_b32 s20, s4, 14
    s_add_u32 s21, s21, s20
    s_lshl_b32 s20, s5, 11
    s_add_u32 s21, s21, s20
    s_add_u32 s21, s21, 4096
    s_and_b32 s18, s3, 6
    s_cmp_lg_u32 s18, 2
    s_cbranch_scc1 L_noib
    buffer_load_dwordx4 v[184:187], v47, s[84:87], s21 offen sc1
L_noib:
    s_waitcnt vmcnt(7)
    s_add_u32 s8, s8, s10
    buffer_load_dwordx4 v[188:191], v1, s[44:47], s8 offen nt
    s_waitcnt vmcnt(7)
    buffer_load_dwordx4 v[192:195], v4, s[60:63], 0 offen offset:1024
    s_waitcnt vmcnt(7)
    s_add_u32 s8, s8, s10
    buffer_load_dwordx4 v[196:199], v1, s[44:47], s8 offen nt
    s_waitcnt vmcnt(7)
    s_add_u32 s8, s8, s10
    buffer_load_dwordx4 v[200:203], v1, s[44:47], s8 offen nt
    s_waitcnt vmcnt(7)
    buffer_load_dwordx4 v[204:207], v4, s[60:63], 0 offen offset:1280
    s_waitcnt vmcnt(7)
    s_add_u32 s8, s8, s10
    buffer_load_dwordx4 v[208:211], v1, s[44:47], s8 offen nt
    s_waitcnt vmcnt(7)
    buffer_load_dwordx4 v[212:215], v4, s[60:63], 0 offen offset:1536
    s_waitcnt vmcnt(7)
    s_add_u32 s8, s8, s10
    buffer_load_dwordx4 v[216:219], v1, s[44:47], s8 offen nt
    s_waitcnt vmcnt(7)
    s_add_u32 s8, s8, s10
    buffer_load_dwordx4 v[220:223], v1, s[44:47], s8 offen nt
    s_waitcnt vmcnt(7)
    buffer_load_dwordx4 v[224:227], v4, s[60:63], 0 offen offset:1792
    s_cmp_lg_u32 s18, 2
    s_cbranch_scc1 L_A
    s_waitcnt vmcnt(10)
    s_mov_b32 s20, 2000000
L_ibchk:
    v_xor_b32 v184, s88, v184
    v_xor_b32 v185, s89, v185
    v_xor_b32 v186, s90, v186
    v_xor_b32 v187, s91, v187
    v_or3_b32 v9, v184, v185, v186
    v_bitop3_b32 v9, v9, v187, v46 bitop3:0xa8
    v_cmp_ne_u32 vcc, 0, v9
    s_cbranch_vccz L_ibok
    s_sub_u32 s20, s20, 1
    s_cbranch_scc1 L_ibok
    buffer_load_dwordx4 v[184:187], v47, s[84:87], s21 offen sc1
    s_waitcnt vmcnt(0)
    s_branch L_ibchk
L_ibok:
    v_permlane16_swap_b32 v184, v186
    v_permlane16_swap_b32 v185, v187
    v_add_f32 v184, v184, v186
    v_add_f32 v185, v185, v187
    v_cvt_pk_bf16_f32 v184, v184, v185
    v_and_b32 v9, 15, v0
    v_lshlrev_b32 v9, 1, v9
    v_bfe_u32 v10, v0, 4, 1
    v_and_b32 v11, 32, v0
    v_add3_u32 v9, v9, v10, v11
    v_lshlrev_b32 v9, 2, v9
    s_cmp_eq_u32 s3, 2
    s_cbranch_scc1 L_wrq
    v_mov_b32 v185, v184
    s_nop 1
    v_permlane32_swap_b32 v184, v185
    s_mov_b32 s20, 0xffff0000
    v_lshlrev_b32 v186, 16, v184
    v_and_b32 v187, s20, v184
    v_mul_f32 v10, 0xbfb8aa3b, v186
    v_mul_f32 v11, 0xbfb8aa3b, v187
    v_exp_f32 v10, v10
    v_exp_f32 v11, v11
    v_add_f32 v10, 1.0, v10
    v_add_f32 v11, 1.0, v11
    v_rcp_f32 v10, v10
    v_rcp_f32 v11, v11
    v_mul_f32 v10, v10, v186
    v_mul_f32 v11, v11, v187
    v_cvt_pk_bf16_f32 v11, v10, v11
    v_lshlrev_b32 v10, 16, v11
    v_and_b32 v11, s20, v11
    v_lshlrev_b32 v186, 16, v185
    v_and_b32 v187, s20, v185
    v_mul_f32 v10, v10, v186
    v_mul_f32 v11, v11, v187
    v_cvt_pk_bf16_f32 v184, v10, v11
    v_add_u32 v9, 256, v9
L_wrq:
    ds_write_b32 v9, v184 offset:0
L_A:
    v_and_b32 v9, 0xf0, v47
    v_lshrrev_b32 v10, 4, v0
    v_lshlrev_b32 v10, 2, v10
    s_lshl_b32 s18, s3, 4
    v_add_u32 v10, s18, v10
    s_waitcnt lgkmcnt(0)
    s_barrier
    ds_read_b128 v[24:27], v9 offset:0
    ds_read_b32 v44, v10 offset:256
    s_add_u32 s8, s8, s10
    buffer_load_dwordx4 v[228:231], v1, s[44:47], s8 offen nt
    s_add_u32 s8, s8, s10
    buffer_load_dwordx4 v[232:235], v1, s[44:47], s8 offen nt
    buffer_load_dwordx4 v[236:239], v4, s[60:63], 0 offen offset:2048
    s_add_u32 s8, s8, s10
    buffer_load_dwordx4 v[240:243], v1, s[44:47], s8 offen nt
    s_add_u32 s8, s8, s10
    buffer_load_dwordx4 v[244:247], v1, s[44:47], s8 offen nt
    buffer_load_dwordx4 v[248:251], v4, s[60:63], 0 offen offset:2304
    s_waitcnt lgkmcnt(0)
    v_dot2_f32_bf16 v36, v48, v24, 0
    v_dot2_f32_bf16 v37, v52, v24, 0
    v_dot2_f32_bf16 v38, v56, v24, 0
    v_dot2_f32_bf16 v39, v60, v24, 0
    v_dot2_f32_bf16 v36, v49, v25, v36
    v_dot2_f32_bf16 v37, v53, v25, v37
    v_dot2_f32_bf16 v38, v57, v25, v38
    v_dot2_f32_bf16 v39, v61, v25, v39
    v_dot2_f32_bf16 v36, v50, v26, v36
    v_dot2_f32_bf16 v37, v54, v26, v37
    v_dot2_f32_bf16 v38, v58, v26, v38
    v_dot2_f32_bf16 v39, v62, v26, v39
    v_dot2_f32_bf16 v36, v51, v27, v36
    v_dot2_f32_bf16 v37, v55, v27, v37
    v_dot2_f32_bf16 v38, v59, v27, v38
    v_dot2_f32_bf16 v39, v63, v27, v39
    v_add_f32_dpp v40, v36, v36 row_ror:8 row_mask:0xf bank_mask:0xf
    v_add_f32_dpp v41, v37, v37 row_ror:8 row_mask:0xf bank_mask:0xf
    s_add_u32 s8, s8, s10
    buffer_load_dwordx4 v[252:255], v1, s[44:47], s8 offen nt
    v_add_f32_dpp v40, v38, v38 row_ror:8 row_mask:0xf bank_mask:0xc
    v_add_f32_dpp v41, v39, v39 row_ror:8 row_mask:0xf bank_mask:0xc
    s_add_u32 s8, s8, s10
    buffer_load_dwordx4 v[92:95], v1, s[44:47], s8 offen nt
    v_add_f32_dpp v28, v40, v40 row_half_mirror row_mask:0xf bank_mask:0xf
    s_nop 1
    v_add_f32_dpp v28, v41, v41 row_half_mirror row_mask:0xf bank_mask:0xa
    s_nop 1
    v_add_f32_dpp v28, v28, v28 quad_perm:[1,0,3,2] row_mask:0xf bank_mask:0xf
    s_nop 1
    v_add_f32_dpp v28, v28, v28 quad_perm:[2,3,0,1] row_mask:0xf bank_mask:0xf
    v_dot2_f32_bf16 v36, v64, v24, 0
    v_dot2_f32_bf16 v37, v68, v24, 0
    v_dot2_f32_bf16 v38, v72, v24, 0
    v_dot2_f32_bf16 v39, v76, v24, 0
    v_dot2_f32_bf16 v36, v65, v25, v36
    v_dot2_f32_bf16 v37, v69, v25, v37
    v_dot2_f32_bf16 v38, v73, v25, v38
    v_dot2_f32_bf16 v39, v77, v25, v39
    v_dot2_f32_bf16 v36, v66, v26, v36
    v_dot2_f32_bf16 v37, v70, v26, v37
    v_dot2_f32_bf16 v38, v74, v26, v38
    v_dot2_f32_bf16 v39, v78, v26, v39
    v_dot2_f32_bf16 v36, v67, v27, v36
    v_dot2_f32_bf16 v37, v71, v27, v37
    v_dot2_f32_bf16 v38, v75, v27, v38
    v_dot2_f32_bf16 v39, v79, v27, v39
    v_add_f32_dpp v40, v36, v36 row_ror:8 row_mask:0xf bank_mask:0xf
    v_add_f32_dpp v41, v37, v37 row_ror:8 row_mask:0xf bank_mask:0xf
    s_add_u32 m0, s64, 98304
    s_mov_b32 s15, 256
    buffer_load_dwordx4 v2, s[56:59], s15 offen  lds
    v_add_f32_dpp v40, v38, v38 row_ror:8 row_mask:0xf bank_mask:0xc
    v_add_f32_dpp v41, v39, v39 row_ror:8 row_mask:0xf bank_mask:0xc
    s_add_u32 s8, s8, s10
    buffer_load_dwordx4 v[96:99], v1, s[44:47], s8 offen nt
    v_add_f32_dpp v29, v40, v40 row_half_mirror row_mask:0xf bank_mask:0xf
    s_nop 1
    v_add_f32_dpp v29, v41, v41 row_half_mirror row_mask:0xf bank_mask:0xa
    s_nop 1
    v_add_f32_dpp v29, v29, v29 quad_perm:[1,0,3,2] row_mask:0xf bank_mask:0xf
    s_nop 1
    v_add_f32_dpp v29, v29, v29 quad_perm:[2,3,0,1] row_mask:0xf bank_mask:0xf
    v_add_u32 v9, 65536, v3
    ds_read_b64_tr_b16 v[100:101], v9 offset:0
    ds_read_b64_tr_b16 v[102:103], v9 offset:1024
    ds_read_b64_tr_b16 v[104:105], v9 offset:8192
    ds_read_b64_tr_b16 v[106:107], v9 offset:9216
    ds_read_b64_tr_b16 v[108:109], v9 offset:16384
    ds_read_b64_tr_b16 v[110:111], v9 offset:17408
    ds_read_b64_tr_b16 v[112:113], v9 offset:24576
    ds_read_b64_tr_b16 v[114:115], v9 offset:25600
    v_dot2_f32_bf16 v36, v80, v24, 0
    v_dot2_f32_bf16 v37, v116, v24, 0
    v_dot2_f32_bf16 v38, v120, v24, 0
    v_dot2_f32_bf16 v39, v124, v24, 0
    v_dot2_f32_bf16 v36, v81, v25, v36
    v_dot2_f32_bf16 v37, v117, v25, v37
    v_dot2_f32_bf16 v38, v121, v25, v38
    v_dot2_f32_bf16 v39, v125, v25, v39
    v_dot2_f32_bf16 v36, v82, v26, v36
    v_dot2_f32_bf16 v37, v118, v26, v37
    v_dot2_f32_bf16 v38, v122, v26, v38
    v_dot2_f32_bf16 v39, v126, v26, v39
    v_dot2_f32_bf16 v36, v83, v27, v36
    v_dot2_f32_bf16 v37, v119, v27, v37
    v_dot2_f32_bf16 v38, v123, v27, v38
    v_dot2_f32_bf16 v39, v127, v27, v39
    v_add_f32_dpp v40, v36, v36 row_ror:8 row_mask:0xf bank_mask:0xf
    v_add_f32_dpp v41, v37, v37 row_ror:8 row_mask:0xf bank_mask:0xf
    s_add_u32 m0, s64, 106496
    s_mov_b32 s15, 41216
    buffer_load_dwordx4 v2, s[56:59], s15 offen  lds
    v_add_f32_dpp v40, v38, v38 row_ror:8 row_mask:0xf bank_mask:0xc
    v_add_f32_dpp v41, v39, v39 row_ror:8 row_mask:0xf bank_mask:0xc
    s_add_u32 s8, s8, s10
    buffer_load_dwordx4 v[88:91], v1, s[44:47], s8 offen nt
    v_add_f32_dpp v30, v40, v40 row_half_mirror row_mask:0xf bank_mask:0xf
    s_nop 1
    v_add_f32_dpp v30, v41, v41 row_half_mirror row_mask:0xf bank_mask:0xa
    s_nop 1
    v_add_f32_dpp v30, v30, v30 quad_perm:[1,0,3,2] row_mask:0xf bank_mask:0xf
    s_nop 1
    v_add_f32_dpp v30, v30, v30 quad_perm:[2,3,0,1] row_mask:0xf bank_mask:0xf
    v_dot2_f32_bf16 v36, v148, v24, 0
    v_dot2_f32_bf16 v37, v156, v24, 0
    v_dot2_f32_bf16 v38, v160, v24, 0
    v_dot2_f32_bf16 v39, v168, v24, 0
    v_dot2_f32_bf16 v36, v149, v25, v36
    v_dot2_f32_bf16 v37, v157, v25, v37
    v_dot2_f32_bf16 v38, v161, v25, v38
    v_dot2_f32_bf16 v39, v169, v25, v39
    v_dot2_f32_bf16 v36, v150, v26, v36
    v_dot2_f32_bf16 v37, v158, v26, v37
    v_dot2_f32_bf16 v38, v162, v26, v38
    v_dot2_f32_bf16 v39, v170, v26, v39
    v_dot2_f32_bf16 v36, v151, v27, v36
    v_dot2_f32_bf16 v37, v159, v27, v37
    v_dot2_f32_bf16 v38, v163, v27, v38
    v_dot2_f32_bf16 v39, v171, v27, v39
    v_add_f32_dpp v40, v36, v36 row_ror:8 row_mask:0xf bank_mask:0xf
    v_add_f32_dpp v41, v37, v37 row_ror:8 row_mask:0xf bank_mask:0xf
    buffer_load_dwordx4 v[84:87], v1, s[48:51], 0 offen nt
    v_add_f32_dpp v40, v38, v38 row_ror:8 row_mask:0xf bank_mask:0xc
    v_add_f32_dpp v41, v39, v39 row_ror:8 row_mask:0xf bank_mask:0xc
    s_add_u32 m0, s64, 114688
    s_mov_b32 s15, 82176
    buffer_load_dwordx4 v2, s[56:59], s15 offen  lds
    v_add_f32_dpp v31, v40, v40 row_half_mirror row_mask:0xf bank_mask:0xf
    s_nop 1
    v_add_f32_dpp v31, v41, v41 row_half_mirror row_mask:0xf bank_mask:0xa
    s_nop 1
    v_add_f32_dpp v31, v31, v31 quad_perm:[1,0,3,2] row_mask:0xf bank_mask:0xf
    s_nop 1
    v_add_f32_dpp v31, v31, v31 quad_perm:[2,3,0,1] row_mask:0xf bank_mask:0xf
    s_waitcnt vmcnt(21)
    v_dot2_f32_bf16 v36, v172, v24, 0
    v_dot2_f32_bf16 v37, v180, v24, 0
    v_dot2_f32_bf16 v38, v188, v24, 0
    v_dot2_f32_bf16 v39, v196, v24, 0
    v_dot2_f32_bf16 v36, v173, v25, v36
    v_dot2_f32_bf16 v37, v181, v25, v37
    v_dot2_f32_bf16 v38, v189, v25, v38
    v_dot2_f32_bf16 v39, v197, v25, v39
    v_dot2_f32_bf16 v36, v174, v26, v36
    v_dot2_f32_bf16 v37, v182, v26, v37
    v_dot2_f32_bf16 v38, v190, v26, v38
    v_dot2_f32_bf16 v39, v198, v26, v39
    v_dot2_f32_bf16 v36, v175, v27, v36
    v_dot2_f32_bf16 v37, v183, v27, v37
    v_dot2_f32_bf16 v38, v191, v27, v38
    v_dot2_f32_bf16 v39, v199, v27, v39
    v_add_f32_dpp v40, v36, v36 row_ror:8 row_mask:0xf bank_mask:0xf
    v_add_f32_dpp v41, v37, v37 row_ror:8 row_mask:0xf bank_mask:0xf
    s_mov_b32 s9, s10
    buffer_load_dwordx4 v[128:131], v1, s[48:51], s9 offen nt
    v_add_f32_dpp v40, v38, v38 row_ror:8 row_mask:0xf bank_mask:0xc
    v_add_f32_dpp v41, v39, v39 row_ror:8 row_mask:0xf bank_mask:0xc
    s_add_u32 s9, s9, s10
    buffer_load_dwordx4 v[132:135], v1, s[48:51], s9 offen nt
    v_add_f32_dpp v32, v40, v40 row_half_mirror row_mask:0xf bank_mask:0xf
    s_nop 1
    v_add_f32_dpp v32, v41, v41 row_half_mirror row_mask:0xf bank_mask:0xa
    s_nop 1
    v_add_f32_dpp v32, v32, v32 quad_perm:[1,0,3,2] row_mask:0xf bank_mask:0xf
    s_nop 1
    v_add_f32_dpp v32, v32, v32 quad_perm:[2,3,0,1] row_mask:0xf bank_mask:0xf
    s_waitcnt vmcnt(17)
    v_dot2_f32_bf16 v36, v200, v24, 0
    v_dot2_f32_bf16 v37, v208, v24, 0
    v_dot2_f32_bf16 v38, v216, v24, 0
    v_dot2_f32_bf16 v39, v220, v24, 0
    v_dot2_f32_bf16 v36, v201, v25, v36
    v_dot2_f32_bf16 v37, v209, v25, v37
    v_dot2_f32_bf16 v38, v217, v25, v38
    v_dot2_f32_bf16 v39, v221, v25, v39
    v_dot2_f32_bf16 v36, v202, v26, v36
    v_dot2_f32_bf16 v37, v210, v26, v37
    v_dot2_f32_bf16 v38, v218, v26, v38
    v_dot2_f32_bf16 v39, v222, v26, v39
    v_dot2_f32_bf16 v36, v203, v27, v36
    v_dot2_f32_bf16 v37, v211, v27, v37
    v_dot2_f32_bf16 v38, v219, v27, v38
    v_dot2_f32_bf16 v39, v223, v27, v39
    v_add_f32_dpp v40, v36, v36 row_ror:8 row_mask:0xf bank_mask:0xf
    v_add_f32_dpp v41, v37, v37 row_ror:8 row_mask:0xf bank_mask:0xf
    s_add_u32 m0, s64, 122880
    s_mov_b32 s15, 123136
    buffer_load_dwordx4 v2, s[56:59], s15 offen  lds
    v_add_f32_dpp v40, v38, v38 row_ror:8 row_mask:0xf bank_mask:0xc
    v_add_f32_dpp v41, v39, v39 row_ror:8 row_mask:0xf bank_mask:0xc
    s_add_u32 s9, s9, s10
    buffer_load_dwordx4 v[136:139], v1, s[48:51], s9 offen nt
    v_add_f32_dpp v33, v40, v40 row_half_mirror row_mask:0xf bank_mask:0xf
    s_nop 1
    v_add_f32_dpp v33, v41, v41 row_half_mirror row_mask:0xf bank_mask:0xa
    s_nop 1
    v_add_f32_dpp v33, v33, v33 quad_perm:[1,0,3,2] row_mask:0xf bank_mask:0xf
    s_nop 1
    v_add_f32_dpp v33, v33, v33 quad_perm:[2,3,0,1] row_mask:0xf bank_mask:0xf
    s_waitcnt vmcnt(13)
    v_dot2_f32_bf16 v36, v228, v24, 0
    v_dot2_f32_bf16 v37, v232, v24, 0
    v_dot2_f32_bf16 v38, v240, v24, 0
    v_dot2_f32_bf16 v39, v244, v24, 0
    v_dot2_f32_bf16 v36, v229, v25, v36
    v_dot2_f32_bf16 v37, v233, v25, v37
    v_dot2_f32_bf16 v38, v241, v25, v38
    v_dot2_f32_bf16 v39, v245, v25, v39
    v_dot2_f32_bf16 v36, v230, v26, v36
    v_dot2_f32_bf16 v37, v234, v26, v37
    v_dot2_f32_bf16 v38, v242, v26, v38
    v_dot2_f32_bf16 v39, v246, v26, v39
    v_dot2_f32_bf16 v36, v231, v27, v36
    v_dot2_f32_bf16 v37, v235, v27, v37
    v_dot2_f32_bf16 v38, v243, v27, v38
    v_dot2_f32_bf16 v39, v247, v27, v39
    v_add_f32_dpp v40, v36, v36 row_ror:8 row_mask:0xf bank_mask:0xf
    v_add_f32_dpp v41, v37, v37 row_ror:8 row_mask:0xf bank_mask:0xf
    s_add_u32 s9, s9, s10
    buffer_load_dwordx4 v[140:143], v1, s[48:51], s9 offen nt
    v_add_f32_dpp v40, v38, v38 row_ror:8 row_mask:0xf bank_mask:0xc
    v_add_f32_dpp v41, v39, v39 row_ror:8 row_mask:0xf bank_mask:0xc
    s_add_u32 m0, s64, 131072
    s_mov_b32 s15, 512
    buffer_load_dwordx4 v2, s[56:59], s15 offen  lds
    v_add_f32_dpp v34, v40, v40 row_half_mirror row_mask:0xf bank_mask:0xf
    s_nop 1
    v_add_f32_dpp v34, v41, v41 row_half_mirror row_mask:0xf bank_mask:0xa
    s_nop 1
    v_add_f32_dpp v34, v34, v34 quad_perm:[1,0,3,2] row_mask:0xf bank_mask:0xf
    s_nop 1
    v_add_f32_dpp v34, v34, v34 quad_perm:[2,3,0,1] row_mask:0xf bank_mask:0xf
    s_add_u32 s9, s9, s10
    buffer_load_dwordx4 v[184:187], v1, s[48:51], s9 offen nt
    s_add_u32 s9, s9, s10
    buffer_load_dwordx4 v[48:51], v1, s[48:51], s9 offen nt
    s_add_u32 m0, s64, 139264
    s_mov_b32 s15, 41472
    buffer_load_dwordx4 v2, s[56:59], s15 offen  lds
    s_add_u32 s9, s9, s10
    buffer_load_dwordx4 v[52:55], v1, s[48:51], s9 offen nt
    s_waitcnt vmcnt(12)
    v_dot2_f32_bf16 v36, v252, v24, 0
    v_dot2_f32_bf16 v37, v92, v24, 0
    v_dot2_f32_bf16 v38, v96, v24, 0
    v_dot2_f32_bf16 v39, v88, v24, 0
    v_dot2_f32_bf16 v36, v253, v25, v36
    v_dot2_f32_bf16 v37, v93, v25, v37
    v_dot2_f32_bf16 v38, v97, v25, v38
    v_dot2_f32_bf16 v39, v89, v25, v39
    v_dot2_f32_bf16 v36, v254, v26, v36
    v_dot2_f32_bf16 v37, v94, v26, v37
    v_dot2_f32_bf16 v38, v98, v26, v38
    v_dot2_f32_bf16 v39, v90, v26, v39
    v_dot2_f32_bf16 v36, v255, v27, v36
    v_dot2_f32_bf16 v37, v95, v27, v37
    v_dot2_f32_bf16 v38, v99, v27, v38
    v_dot2_f32_bf16 v39, v91, v27, v39
    v_add_f32_dpp v40, v36, v36 row_ror:8 row_mask:0xf bank_mask:0xf
    v_add_f32_dpp v41, v37, v37 row_ror:8 row_mask:0xf bank_mask:0xf
    s_add_u32 m0, s64, 147456
    s_mov_b32 s15, 82432
    buffer_load_dwordx4 v2, s[56:59], s15 offen  lds
    v_add_f32_dpp v40, v38, v38 row_ror:8 row_mask:0xf bank_mask:0xc
    v_add_f32_dpp v41, v39, v39 row_ror:8 row_mask:0xf bank_mask:0xc
    s_add_u32 s9, s9, s10
    buffer_load_dwordx4 v[56:59], v1, s[48:51], s9 offen nt
    v_add_f32_dpp v35, v40, v40 row_half_mirror row_mask:0xf bank_mask:0xf
    s_nop 1
    v_add_f32_dpp v35, v41, v41 row_half_mirror row_mask:0xf bank_mask:0xa
    s_nop 1
    v_add_f32_dpp v35, v35, v35 quad_perm:[1,0,3,2] row_mask:0xf bank_mask:0xf
    s_nop 1
    v_add_f32_dpp v35, v35, v35 quad_perm:[2,3,0,1] row_mask:0xf bank_mask:0xf
    s_mov_b32 s18, 0xffff0000
    s_mov_b32 s19, 0x3db504f3
    v_cvt_pk_bf16_f32 v29, v28, v29
    v_lshlrev_b32 v28, 16, v29
    v_and_b32 v29, s18, v29
    v_mul_f32 v28, s19, v28
    v_mul_f32 v29, s19, v29
    v_cvt_pk_bf16_f32 v29, v28, v29
    v_lshlrev_b32 v28, 16, v29
    v_and_b32 v29, s18, v29
    v_cvt_pk_bf16_f32 v31, v30, v31
    v_lshlrev_b32 v30, 16, v31
    v_and_b32 v31, s18, v31
    v_mul_f32 v30, s19, v30
    v_mul_f32 v31, s19, v31
    v_cvt_pk_bf16_f32 v31, v30, v31
    v_lshlrev_b32 v30, 16, v31
    v_and_b32 v31, s18, v31
    v_cvt_pk_bf16_f32 v33, v32, v33
    v_lshlrev_b32 v32, 16, v33
    v_and_b32 v33, s18, v33
    v_mul_f32 v32, s19, v32
    v_mul_f32 v33, s19, v33
    v_cvt_pk_bf16_f32 v33, v32, v33
    v_lshlrev_b32 v32, 16, v33
    v_and_b32 v33, s18, v33
    v_cvt_pk_bf16_f32 v35, v34, v35
    v_lshlrev_b32 v34, 16, v35
    v_and_b32 v35, s18, v35
    v_mul_f32 v34, s19, v34
    v_mul_f32 v35, s19, v35
    v_cvt_pk_bf16_f32 v35, v34, v35
    v_lshlrev_b32 v34, 16, v35
    v_and_b32 v35, s18, v35
    v_max3_f32 v36, v28, v29, v30
    v_max3_f32 v37, v31, v32, v33
    v_max3_f32 v36, v36, v34, v35
    v_max_f32 v36, v36, v37
    s_nop 1
    v_max_f32_dpp v36, v36, v36 row_ror:4 row_mask:0xf bank_mask:0xf
    s_nop 1
    v_max_f32_dpp v36, v36, v36 row_ror:8 row_mask:0xf bank_mask:0xf
    s_mov_b32 s19, 0x3fb8aa3b
    v_sub_f32 v28, v28, v36
    v_sub_f32 v29, v29, v36
    v_sub_f32 v30, v30, v36
    v_sub_f32 v31, v31, v36
    v_sub_f32 v32, v32, v36
    v_sub_f32 v33, v33, v36
    v_sub_f32 v34, v34, v36
    v_sub_f32 v35, v35, v36
    v_mul_f32 v28, s19, v28
    v_mul_f32 v29, s19, v29
    v_mul_f32 v30, s19, v30
    v_mul_f32 v31, s19, v31
    v_mul_f32 v32, s19, v32
    v_mul_f32 v33, s19, v33
    v_mul_f32 v34, s19, v34
    v_mul_f32 v35, s19, v35
    v_exp_f32 v28, v28
    v_exp_f32 v29, v29
    v_exp_f32 v30, v30
    v_exp_f32 v31, v31
    v_exp_f32 v32, v32
    v_exp_f32 v33, v33
    v_exp_f32 v34, v34
    v_exp_f32 v35, v35
    v_add_f32 v37, v28, v29
    v_add_f32 v37, v37, v30
    v_add_f32 v37, v37, v31
    v_add_f32 v37, v37, v32
    v_add_f32 v37, v37, v33
    v_add_f32 v37, v37, v34
    v_add_f32 v37, v37, v35
    s_nop 1
    v_add_f32_dpp v37, v37, v37 row_ror:4 row_mask:0xf bank_mask:0xf
    s_nop 1
    v_add_f32_dpp v37, v37, v37 row_ror:8 row_mask:0xf bank_mask:0xf
    s_and_b32 s20, s3, 3
    s_lshl_b32 s20, s20, 6
    s_lshr_b32 s21, s3, 2
    s_lshl_b32 s21, s21, 3
    s_add_u32 s20, s20, s21
    v_and_b32 v9, 48, v0
    v_add_u32 v9, s20, v9
    s_mov_b32 exec_lo, 0x00010001
    s_mov_b32 exec_hi, 0x00010001
    ds_write_b64 v9, v[36:37] offset:512
    s_mov_b64 exec, -1
    s_add_u32 s9, s9, s10
    buffer_load_dwordx4 v[60:63], v1, s[48:51], s9 offen nt
    s_add_u32 m0, s64, 155648
    s_mov_b32 s15, 123392
    buffer_load_dwordx4 v2, s[56:59], s15 offen  lds
    s_add_u32 s9, s9, s10
    buffer_load_dwordx4 v[64:67], v1, s[48:51], s9 offen nt
    s_add_u32 s9, s9, s10
    buffer_load_dwordx4 v[68:71], v1, s[48:51], s9 offen nt
    s_waitcnt vmcnt(13)
    v_and_b32 v9, 0xf0, v47
    s_waitcnt lgkmcnt(0)
    s_barrier
    ds_read_b128 v[72:75], v9 offset:512
    s_add_u32 m0, s64, 24576
    s_mov_b32 s15, 768
    buffer_load_dwordx4 v2, s[56:59], s15 offen  lds
    s_add_u32 s9, s9, s10
    buffer_load_dwordx4 v[76:79], v1, s[48:51], s9 offen nt
    s_waitcnt lgkmcnt(0)
    v_add_u32 v9, 98304, v3
    ds_read_b64_tr_b16 v[116:117], v9 offset:0
    ds_read_b64_tr_b16 v[118:119], v9 offset:1024
    ds_read_b64_tr_b16 v[120:121], v9 offset:8192
    ds_read_b64_tr_b16 v[122:123], v9 offset:9216
    ds_read_b64_tr_b16 v[156:157], v9 offset:16384
    ds_read_b64_tr_b16 v[158:159], v9 offset:17408
    ds_read_b64_tr_b16 v[160:161], v9 offset:24576
    ds_read_b64_tr_b16 v[162:163], v9 offset:25600
    v_max_f32 v38, v72, v74
    s_nop 1
    v_max_f32_dpp v38, v38, v38 row_ror:1 row_mask:0xf bank_mask:0xf
    s_nop 1
    v_max_f32_dpp v38, v38, v38 row_ror:2 row_mask:0xf bank_mask:0xf
    s_nop 1
    v_max_f32_dpp v38, v38, v38 row_ror:4 row_mask:0xf bank_mask:0xf
    s_nop 1
    v_max_f32_dpp v38, v38, v38 row_ror:8 row_mask:0xf bank_mask:0xf
    v_sub_f32 v72, v72, v38
    v_sub_f32 v74, v74, v38
    v_sub_f32 v40, v36, v38
    v_mul_f32 v72, s19, v72
    v_mul_f32 v74, s19, v74
    v_mul_f32 v40, s19, v40
    v_exp_f32 v72, v72
    v_exp_f32 v74, v74
    v_exp_f32 v40, v40
    v_mul_f32 v39, v72, v73
    v_fmac_f32 v39, v74, v75
    s_nop 1
    v_add_f32_dpp v39, v39, v39 row_ror:1 row_mask:0xf bank_mask:0xf
    s_nop 1
    v_add_f32_dpp v39, v39, v39 row_ror:2 row_mask:0xf bank_mask:0xf
    s_nop 1
    v_add_f32_dpp v39, v39, v39 row_ror:4 row_mask:0xf bank_mask:0xf
    s_nop 1
    v_add_f32_dpp v39, v39, v39 row_ror:8 row_mask:0xf bank_mask:0xf
    v_rcp_f32 v39, v39
    s_nop 0
    v_mul_f32 v40, v40, v39
    v_mul_f32 v28, v28, v40
    v_mul_f32 v29, v29, v40
    v_mul_f32 v30, v30, v40
    v_mul_f32 v31, v31, v40
    v_mul_f32 v32, v32, v40
    v_mul_f32 v33, v33, v40
    v_mul_f32 v34, v34, v40
    v_mul_f32 v35, v35, v40
    v_cvt_pk_bf16_f32 v28, v28, v28
    v_cvt_pk_bf16_f32 v29, v29, v29
    v_cvt_pk_bf16_f32 v30, v30, v30
    v_cvt_pk_bf16_f32 v31, v31, v31
    v_cvt_pk_bf16_f32 v32, v32, v32
    v_cvt_pk_bf16_f32 v33, v33, v33
    v_cvt_pk_bf16_f32 v34, v34, v34
    v_cvt_pk_bf16_f32 v35, v35, v35
    v_and_b32_dpp v16, v28, v5 row_newbcast:0 row_mask:0xf bank_mask:0xf
    v_and_b32_dpp v17, v28, v6 row_newbcast:0 row_mask:0xf bank_mask:0xf
    v_and_b32_dpp v18, v28, v7 row_newbcast:0 row_mask:0xf bank_mask:0xf
    v_and_b32_dpp v19, v28, v8 row_newbcast:0 row_mask:0xf bank_mask:0xf
    s_nop 1
    v_mfma_f32_16x16x32_bf16 v[20:23], v[16:19], v[84:87], 0
    s_mov_b32 s20, 0x01000100
    s_mov_b32 s21, 0x03020302
    v_perm_b32 v9, v44, v44, s20
    v_perm_b32 v10, v44, v44, s21
    v_and_b32 v12, v9, v5
    v_and_b32 v13, v9, v6
    v_and_b32 v14, v9, v7
    v_and_b32 v15, v9, v8
    v_and_b32 v16, v10, v5
    v_and_b32 v17, v10, v6
    v_and_b32 v18, v10, v7
    v_and_b32 v19, v10, v8
    v_mfma_f32_16x16x32_bf16 v[80:83], v[12:15], v[144:147], 0
    s_nop 0
    v_mfma_f32_16x16x32_bf16 v[80:83], v[16:19], v[204:207], v[80:83]
    v_mfma_f32_16x16x32_bf16 v[124:127], v[12:15], v[152:155], 0
    v_mfma_f32_16x16x32_bf16 v[124:127], v[16:19], v[212:215], v[124:127]
    v_mfma_f32_16x16x32_bf16 v[148:151], v[12:15], v[164:167], 0
    v_mfma_f32_16x16x32_bf16 v[148:151], v[16:19], v[224:227], v[148:151]
    v_mfma_f32_16x16x32_bf16 v[168:171], v[12:15], v[176:179], 0
    v_mfma_f32_16x16x32_bf16 v[168:171], v[16:19], v[236:239], v[168:171]
    v_mfma_f32_16x16x32_bf16 v[172:175], v[12:15], v[192:195], 0
    v_mfma_f32_16x16x32_bf16 v[172:175], v[16:19], v[248:251], v[172:175]
    s_mul_i32 s20, s3, 2560
    v_and_b32 v9, 15, v0
    v_lshlrev_b32 v9, 5, v9
    v_and_b32 v10, 16, v0
    v_add3_u32 v9, v9, v10, s20
    s_mov_b32 exec_hi, 0
    v_mul_f32 v80, s43, v80
    v_mul_f32 v81, s43, v81
    v_mul_f32 v82, s43, v82
    v_mul_f32 v83, s43, v83
    ds_write_b128 v9, v[80:83] offset:4096
    v_mul_f32 v124, s43, v124
    v_mul_f32 v125, s43, v125
    v_mul_f32 v126, s43, v126
    v_mul_f32 v127, s43, v127
    ds_write_b128 v9, v[124:127] offset:4608
    v_mul_f32 v148, s43, v148
    v_mul_f32 v149, s43, v149
    v_mul_f32 v150, s43, v150
    v_mul_f32 v151, s43, v151
    ds_write_b128 v9, v[148:151] offset:5120
    v_mul_f32 v168, s43, v168
    v_mul_f32 v169, s43, v169
    v_mul_f32 v170, s43, v170
    v_mul_f32 v171, s43, v171
    ds_write_b128 v9, v[168:171] offset:5632
    v_mul_f32 v172, s43, v172
    v_mul_f32 v173, s43, v173
    v_mul_f32 v174, s43, v174
    v_mul_f32 v175, s43, v175
    ds_write_b128 v9, v[172:175] offset:6144
    s_mov_b64 exec, -1
    s_waitcnt lgkmcnt(0)
    v_and_b32_dpp v12, v28, v5 row_newbcast:4 row_mask:0xf bank_mask:0xf
    v_and_b32_dpp v13, v28, v6 row_newbcast:4 row_mask:0xf bank_mask:0xf
    v_and_b32_dpp v14, v28, v7 row_newbcast:4 row_mask:0xf bank_mask:0xf
    v_and_b32_dpp v15, v28, v8 row_newbcast:4 row_mask:0xf bank_mask:0xf
    s_nop 1
    v_mfma_f32_16x16x32_bf16 v[20:23], v[12:15], v[128:131], v[20:23]
    v_and_b32_dpp v16, v28, v5 row_newbcast:8 row_mask:0xf bank_mask:0xf
    v_and_b32_dpp v17, v28, v6 row_newbcast:8 row_mask:0xf bank_mask:0xf
    v_and_b32_dpp v18, v28, v7 row_newbcast:8 row_mask:0xf bank_mask:0xf
    v_and_b32_dpp v19, v28, v8 row_newbcast:8 row_mask:0xf bank_mask:0xf
    s_nop 1
    v_mfma_f32_16x16x32_bf16 v[20:23], v[16:19], v[132:135], v[20:23]
    v_and_b32_dpp v12, v28, v5 row_newbcast:12 row_mask:0xf bank_mask:0xf
    v_and_b32_dpp v13, v28, v6 row_newbcast:12 row_mask:0xf bank_mask:0xf
    v_and_b32_dpp v14, v28, v7 row_newbcast:12 row_mask:0xf bank_mask:0xf
    v_and_b32_dpp v15, v28, v8 row_newbcast:12 row_mask:0xf bank_mask:0xf
    s_waitcnt vmcnt(14)
    s_nop 0
    v_mfma_f32_16x16x32_bf16 v[20:23], v[12:15], v[136:139], v[20:23]
    v_and_b32_dpp v16, v29, v5 row_newbcast:0 row_mask:0xf bank_mask:0xf
    v_and_b32_dpp v17, v29, v6 row_newbcast:0 row_mask:0xf bank_mask:0xf
    v_and_b32_dpp v18, v29, v7 row_newbcast:0 row_mask:0xf bank_mask:0xf
    v_and_b32_dpp v19, v29, v8 row_newbcast:0 row_mask:0xf bank_mask:0xf
    s_waitcnt vmcnt(13)
    s_nop 0
    v_mfma_f32_16x16x32_bf16 v[20:23], v[16:19], v[140:143], v[20:23]
    s_add_u32 s9, s9, s10
    buffer_load_dwordx4 v[180:183], v1, s[48:51], s9 offen nt
    v_and_b32_dpp v12, v29, v5 row_newbcast:4 row_mask:0xf bank_mask:0xf
    v_and_b32_dpp v13, v29, v6 row_newbcast:4 row_mask:0xf bank_mask:0xf
    v_and_b32_dpp v14, v29, v7 row_newbcast:4 row_mask:0xf bank_mask:0xf
    v_and_b32_dpp v15, v29, v8 row_newbcast:4 row_mask:0xf bank_mask:0xf
    s_waitcnt vmcnt(12)
    s_nop 0
    v_mfma_f32_16x16x32_bf16 v[20:23], v[12:15], v[184:187], v[20:23]
    s_add_u32 m0, s64, 32768
    s_mov_b32 s15, 41728
    buffer_load_dwordx4 v2, s[56:59], s15 offen  lds
    v_and_b32_dpp v16, v29, v5 row_newbcast:8 row_mask:0xf bank_mask:0xf
    v_and_b32_dpp v17, v29, v6 row_newbcast:8 row_mask:0xf bank_mask:0xf
    v_and_b32_dpp v18, v29, v7 row_newbcast:8 row_mask:0xf bank_mask:0xf
    v_and_b32_dpp v19, v29, v8 row_newbcast:8 row_mask:0xf bank_mask:0xf
    s_waitcnt vmcnt(12)
    s_nop 0
    v_mfma_f32_16x16x32_bf16 v[20:23], v[16:19], v[48:51], v[20:23]
    s_add_u32 s9, s9, s10
    buffer_load_dwordx4 v[188:191], v1, s[48:51], s9 offen nt
    s_add_u32 s9, s9, s10
    buffer_load_dwordx4 v[196:199], v1, s[48:51], s9 offen nt
    v_and_b32_dpp v12, v29, v5 row_newbcast:12 row_mask:0xf bank_mask:0xf
    v_and_b32_dpp v13, v29, v6 row_newbcast:12 row_mask:0xf bank_mask:0xf
    v_and_b32_dpp v14, v29, v7 row_newbcast:12 row_mask:0xf bank_mask:0xf
    v_and_b32_dpp v15, v29, v8 row_newbcast:12 row_mask:0xf bank_mask:0xf
    s_waitcnt vmcnt(12)
    s_nop 0
    v_mfma_f32_16x16x32_bf16 v[20:23], v[12:15], v[52:55], v[20:23]
    s_add_u32 m0, s64, 40960
    s_mov_b32 s15, 82688
    buffer_load_dwordx4 v2, s[56:59], s15 offen  lds
    s_add_u32 s9, s9, s10
    buffer_load_dwordx4 v[200:203], v1, s[48:51], s9 offen nt
    v_and_b32_dpp v16, v30, v5 row_newbcast:0 row_mask:0xf bank_mask:0xf
    v_and_b32_dpp v17, v30, v6 row_newbcast:0 row_mask:0xf bank_mask:0xf
    v_and_b32_dpp v18, v30, v7 row_newbcast:0 row_mask:0xf bank_mask:0xf
    v_and_b32_dpp v19, v30, v8 row_newbcast:0 row_mask:0xf bank_mask:0xf
    s_waitcnt vmcnt(12)
    s_nop 0
    v_mfma_f32_16x16x32_bf16 v[20:23], v[16:19], v[56:59], v[20:23]
    s_add_u32 m0, s64, 49152
    s_mov_b32 s15, 123648
    buffer_load_dwordx4 v2, s[56:59], s15 offen  lds
    v_and_b32_dpp v12, v30, v5 row_newbcast:4 row_mask:0xf bank_mask:0xf
    v_and_b32_dpp v13, v30, v6 row_newbcast:4 row_mask:0xf bank_mask:0xf
    v_and_b32_dpp v14, v30, v7 row_newbcast:4 row_mask:0xf bank_mask:0xf
    v_and_b32_dpp v15, v30, v8 row_newbcast:4 row_mask:0xf bank_mask:0xf
    s_waitcnt vmcnt(12)
    s_nop 0
    v_mfma_f32_16x16x32_bf16 v[20:23], v[12:15], v[60:63], v[20:23]
    s_add_u32 s9, s9, s10
    buffer_load_dwordx4 v[208:211], v1, s[48:51], s9 offen nt
    s_add_u32 s9, s9, s10
    buffer_load_dwordx4 v[216:219], v1, s[48:51], s9 offen nt
    v_and_b32_dpp v16, v30, v5 row_newbcast:8 row_mask:0xf bank_mask:0xf
    v_and_b32_dpp v17, v30, v6 row_newbcast:8 row_mask:0xf bank_mask:0xf
    v_and_b32_dpp v18, v30, v7 row_newbcast:8 row_mask:0xf bank_mask:0xf
    v_and_b32_dpp v19, v30, v8 row_newbcast:8 row_mask:0xf bank_mask:0xf
    s_waitcnt vmcnt(12)
    s_nop 0
    v_mfma_f32_16x16x32_bf16 v[20:23], v[16:19], v[64:67], v[20:23]
    s_add_u32 m0, s64, 65536
    s_mov_b32 s15, 1024
    buffer_load_dwordx4 v2, s[56:59], s15 offen  lds
    v_and_b32_dpp v12, v30, v5 row_newbcast:12 row_mask:0xf bank_mask:0xf
    v_and_b32_dpp v13, v30, v6 row_newbcast:12 row_mask:0xf bank_mask:0xf
    v_and_b32_dpp v14, v30, v7 row_newbcast:12 row_mask:0xf bank_mask:0xf
    v_and_b32_dpp v15, v30, v8 row_newbcast:12 row_mask:0xf bank_mask:0xf
    s_waitcnt vmcnt(12)
    s_nop 0
    v_mfma_f32_16x16x32_bf16 v[20:23], v[12:15], v[68:71], v[20:23]
    s_add_u32 s9, s9, s10
    buffer_load_dwordx4 v[220:223], v1, s[48:51], s9 offen nt
    s_add_u32 s9, s9, s10
    buffer_load_dwordx4 v[228:231], v1, s[48:51], s9 offen nt
    v_and_b32_dpp v16, v31, v5 row_newbcast:0 row_mask:0xf bank_mask:0xf
    v_and_b32_dpp v17, v31, v6 row_newbcast:0 row_mask:0xf bank_mask:0xf
    v_and_b32_dpp v18, v31, v7 row_newbcast:0 row_mask:0xf bank_mask:0xf
    v_and_b32_dpp v19, v31, v8 row_newbcast:0 row_mask:0xf bank_mask:0xf
    s_waitcnt vmcnt(12)
    s_nop 0
    v_mfma_f32_16x16x32_bf16 v[20:23], v[16:19], v[76:79], v[20:23]
    s_add_u32 m0, s64, 73728
    s_mov_b32 s15, 41984
    buffer_load_dwordx4 v2, s[56:59], s15 offen  lds
    v_and_b32_dpp v12, v31, v5 row_newbcast:4 row_mask:0xf bank_mask:0xf
    v_and_b32_dpp v13, v31, v6 row_newbcast:4 row_mask:0xf bank_mask:0xf
    v_and_b32_dpp v14, v31, v7 row_newbcast:4 row_mask:0xf bank_mask:0xf
    v_and_b32_dpp v15, v31, v8 row_newbcast:4 row_mask:0xf bank_mask:0xf
    s_waitcnt vmcnt(12)
    s_nop 0
    v_mfma_f32_16x16x32_bf16 v[20:23], v[12:15], v[180:183], v[20:23]
    s_add_u32 s9, s9, s10
    buffer_load_dwordx4 v[232:235], v1, s[48:51], s9 offen nt
    s_add_u32 s9, s9, s10
    buffer_load_dwordx4 v[240:243], v1, s[48:51], s9 offen nt
    v_and_b32_dpp v16, v31, v5 row_newbcast:8 row_mask:0xf bank_mask:0xf
    v_and_b32_dpp v17, v31, v6 row_newbcast:8 row_mask:0xf bank_mask:0xf
    v_and_b32_dpp v18, v31, v7 row_newbcast:8 row_mask:0xf bank_mask:0xf
    v_and_b32_dpp v19, v31, v8 row_newbcast:8 row_mask:0xf bank_mask:0xf
    s_waitcnt vmcnt(12)
    s_nop 0
    v_mfma_f32_16x16x32_bf16 v[20:23], v[16:19], v[188:191], v[20:23]
    s_add_u32 m0, s64, 81920
    s_mov_b32 s15, 82944
    buffer_load_dwordx4 v2, s[56:59], s15 offen  lds
    v_and_b32_dpp v12, v31, v5 row_newbcast:12 row_mask:0xf bank_mask:0xf
    v_and_b32_dpp v13, v31, v6 row_newbcast:12 row_mask:0xf bank_mask:0xf
    v_and_b32_dpp v14, v31, v7 row_newbcast:12 row_mask:0xf bank_mask:0xf
    v_and_b32_dpp v15, v31, v8 row_newbcast:12 row_mask:0xf bank_mask:0xf
    s_waitcnt vmcnt(12)
    s_nop 0
    v_mfma_f32_16x16x32_bf16 v[20:23], v[12:15], v[196:199], v[20:23]
    s_add_u32 s9, s9, s10
    buffer_load_dwordx4 v[244:247], v1, s[48:51], s9 offen nt
    s_add_u32 s9, s9, s10
    buffer_load_dwordx4 v[252:255], v1, s[48:51], s9 offen nt
    v_and_b32_dpp v16, v32, v5 row_newbcast:0 row_mask:0xf bank_mask:0xf
    v_and_b32_dpp v17, v32, v6 row_newbcast:0 row_mask:0xf bank_mask:0xf
    v_and_b32_dpp v18, v32, v7 row_newbcast:0 row_mask:0xf bank_mask:0xf
    v_and_b32_dpp v19, v32, v8 row_newbcast:0 row_mask:0xf bank_mask:0xf
    s_waitcnt vmcnt(12)
    s_nop 0
    v_mfma_f32_16x16x32_bf16 v[20:23], v[16:19], v[200:203], v[20:23]
    s_add_u32 m0, s64, 90112
    s_mov_b32 s15, 123904
    buffer_load_dwordx4 v2, s[56:59], s15 offen  lds
    s_add_u32 s9, s9, s10
    buffer_load_dwordx4 v[92:95], v1, s[48:51], s9 offen nt
    v_and_b32_dpp v12, v32, v5 row_newbcast:4 row_mask:0xf bank_mask:0xf
    v_and_b32_dpp v13, v32, v6 row_newbcast:4 row_mask:0xf bank_mask:0xf
    v_and_b32_dpp v14, v32, v7 row_newbcast:4 row_mask:0xf bank_mask:0xf
    v_and_b32_dpp v15, v32, v8 row_newbcast:4 row_mask:0xf bank_mask:0xf
    s_waitcnt vmcnt(12)
    s_nop 0
    v_mfma_f32_16x16x32_bf16 v[20:23], v[12:15], v[208:211], v[20:23]
    v_lshrrev_b32 v45, 4, v0
    v_mul_u32_u24 v45, 5120, v45
    v_and_b32 v11, 15, v0
    v_lshlrev_b32 v11, 2, v11
    s_lshl_b32 s20, s3, 6
    v_add3_u32 v45, v45, v11, s20
    s_waitcnt lgkmcnt(0)
    s_barrier
    s_add_u32 s9, s9, s10
    buffer_load_dwordx4 v[96:99], v1, s[48:51], s9 offen nt
    s_add_u32 s9, s9, s10
    buffer_load_dwordx4 v[88:91], v1, s[48:51], s9 offen nt
    s_add_u32 s9, s9, s10
    buffer_load_dwordx4 v[72:75], v1, s[48:51], s9 offen nt
    s_add_u32 s9, s9, s10
    buffer_load_dwordx4 v[84:87], v1, s[48:51], s9 offen nt
    v_add_u32 v9, 131072, v3
    ds_read_b64_tr_b16 v[144:145], v9 offset:0
    ds_read_b64_tr_b16 v[146:147], v9 offset:1024
    ds_read_b64_tr_b16 v[148:149], v9 offset:8192
    ds_read_b64_tr_b16 v[150:151], v9 offset:9216
    ds_read_b64_tr_b16 v[204:205], v9 offset:16384
    ds_read_b64_tr_b16 v[206:207], v9 offset:17408
    ds_read_b64_tr_b16 v[208:209], v9 offset:24576
    ds_read_b64_tr_b16 v[210:211], v9 offset:25600
    v_and_b32_dpp v16, v32, v5 row_newbcast:8 row_mask:0xf bank_mask:0xf
    v_and_b32_dpp v17, v32, v6 row_newbcast:8 row_mask:0xf bank_mask:0xf
    v_and_b32_dpp v18, v32, v7 row_newbcast:8 row_mask:0xf bank_mask:0xf
    v_and_b32_dpp v19, v32, v8 row_newbcast:8 row_mask:0xf bank_mask:0xf
    s_waitcnt vmcnt(15)
    s_nop 0
    v_mfma_f32_16x16x32_bf16 v[20:23], v[16:19], v[216:219], v[20:23]
    ds_read2st64_b32 v[152:153], v45 offset0:16 offset1:26
    v_mov_b32 v154, 0
    v_mov_b32 v155, 0
    ds_read2st64_b32 v[212:213], v45 offset0:18 offset1:28
    v_mov_b32 v214, 0
    v_mov_b32 v215, 0
    ds_read2st64_b32 v[164:165], v45 offset0:20 offset1:30
    v_mov_b32 v166, 0
    v_mov_b32 v167, 0
    ds_read2st64_b32 v[224:225], v45 offset0:22 offset1:32
    v_mov_b32 v226, 0
    v_mov_b32 v227, 0
    ds_read2st64_b32 v[176:177], v45 offset0:24 offset1:34
    v_mov_b32 v178, 0
    v_mov_b32 v179, 0
    v_and_b32_dpp v12, v32, v5 row_newbcast:12 row_mask:0xf bank_mask:0xf
    v_and_b32_dpp v13, v32, v6 row_newbcast:12 row_mask:0xf bank_mask:0xf
    v_and_b32_dpp v14, v32, v7 row_newbcast:12 row_mask:0xf bank_mask:0xf
    v_and_b32_dpp v15, v32, v8 row_newbcast:12 row_mask:0xf bank_mask:0xf
    s_waitcnt vmcnt(13)
    s_nop 0
    v_mfma_f32_16x16x32_bf16 v[20:23], v[12:15], v[220:223], v[20:23]
    v_and_b32_dpp v16, v33, v5 row_newbcast:0 row_mask:0xf bank_mask:0xf
    v_and_b32_dpp v17, v33, v6 row_newbcast:0 row_mask:0xf bank_mask:0xf
    v_and_b32_dpp v18, v33, v7 row_newbcast:0 row_mask:0xf bank_mask:0xf
    v_and_b32_dpp v19, v33, v8 row_newbcast:0 row_mask:0xf bank_mask:0xf
    s_waitcnt vmcnt(12)
    s_nop 0
    v_mfma_f32_16x16x32_bf16 v[20:23], v[16:19], v[228:231], v[20:23]
    v_add_u32 v9, 24576, v3
    ds_read_b64_tr_b16 v[192:193], v9 offset:0
    ds_read_b64_tr_b16 v[194:195], v9 offset:1024
    ds_read_b64_tr_b16 v[196:197], v9 offset:8192
    ds_read_b64_tr_b16 v[198:199], v9 offset:9216
    ds_read_b64_tr_b16 v[124:125], v9 offset:16384
    ds_read_b64_tr_b16 v[126:127], v9 offset:17408
    ds_read_b64_tr_b16 v[128:129], v9 offset:24576
    ds_read_b64_tr_b16 v[130:131], v9 offset:25600
    s_add_u32 s9, s9, s10
    buffer_load_dwordx4 v[236:239], v1, s[48:51], s9 offen nt
    s_add_u32 s9, s9, s10
    buffer_load_dwordx4 v[248:251], v1, s[48:51], s9 offen nt
    v_and_b32_dpp v12, v33, v5 row_newbcast:4 row_mask:0xf bank_mask:0xf
    v_and_b32_dpp v13, v33, v6 row_newbcast:4 row_mask:0xf bank_mask:0xf
    v_and_b32_dpp v14, v33, v7 row_newbcast:4 row_mask:0xf bank_mask:0xf
    v_and_b32_dpp v15, v33, v8 row_newbcast:4 row_mask:0xf bank_mask:0xf
    s_waitcnt vmcnt(12)
    s_nop 0
    v_mfma_f32_16x16x32_bf16 v[20:23], v[12:15], v[232:235], v[20:23]
    v_and_b32_dpp v16, v33, v5 row_newbcast:8 row_mask:0xf bank_mask:0xf
    v_and_b32_dpp v17, v33, v6 row_newbcast:8 row_mask:0xf bank_mask:0xf
    v_and_b32_dpp v18, v33, v7 row_newbcast:8 row_mask:0xf bank_mask:0xf
    v_and_b32_dpp v19, v33, v8 row_newbcast:8 row_mask:0xf bank_mask:0xf
    s_waitcnt vmcnt(11)
    s_nop 0
    v_mfma_f32_16x16x32_bf16 v[20:23], v[16:19], v[240:243], v[20:23]
    v_and_b32_dpp v12, v33, v5 row_newbcast:12 row_mask:0xf bank_mask:0xf
    v_and_b32_dpp v13, v33, v6 row_newbcast:12 row_mask:0xf bank_mask:0xf
    v_and_b32_dpp v14, v33, v7 row_newbcast:12 row_mask:0xf bank_mask:0xf
    v_and_b32_dpp v15, v33, v8 row_newbcast:12 row_mask:0xf bank_mask:0xf
    s_waitcnt vmcnt(9)
    s_nop 0
    v_mfma_f32_16x16x32_bf16 v[20:23], v[12:15], v[244:247], v[20:23]
    v_and_b32_dpp v16, v34, v5 row_newbcast:0 row_mask:0xf bank_mask:0xf
    v_and_b32_dpp v17, v34, v6 row_newbcast:0 row_mask:0xf bank_mask:0xf
    v_and_b32_dpp v18, v34, v7 row_newbcast:0 row_mask:0xf bank_mask:0xf
    v_and_b32_dpp v19, v34, v8 row_newbcast:0 row_mask:0xf bank_mask:0xf
    s_waitcnt vmcnt(8)
    s_nop 0
    v_mfma_f32_16x16x32_bf16 v[20:23], v[16:19], v[252:255], v[20:23]
    s_mul_i32 s18, s3, 272
    v_and_b32 v9, 0xf0, v47
    v_bfe_u32 v10, v0, 4, 1
    v_lshl_add_u32 v9, v10, 3, v9
    v_lshrrev_b32 v9, 1, v9
    s_add_u32 s18, s18, 1024
    v_add_u32 v9, s18, v9
    v_and_b32 v10, 7, v0
    v_mul_u32_u24 v10, 272, v10
    v_and_b32 v43, 48, v0
    v_add_u32 v10, v10, v43
    v_and_b32 v42, 8, v0
    v_lshl_add_u32 v10, v42, 4, v10
    v_cmp_eq_u32 vcc, 0, v42
    v_mov_b32 v39, 0xeeee
    v_mov_b32 v38, 0x4444
    v_cndmask_b32 v39, v39, v38, vcc
    v_and_b32 v43, 3, v0
    v_lshlrev_b32 v43, 3, v43
    v_lshrrev_b32 v43, v43, s92
    v_and_b32 v42, 15, v0
    v_lshlrev_b32 v42, 2, v42
    v_lshrrev_b32 v40, 4, v0
    v_lshl_add_u32 v42, v40, 9, v42
    v_add_u32 v41, 65536, v3
    s_mul_i32 s18, s6, 2560
    s_mul_i32 s19, s3, 64
    s_add_u32 s18, s18, s19
    s_add_u32 s18, s18, 528384
    s_mov_b32 s60, 0x00010001
    s_mov_b32 s61, s60
    s_mov_b32 s62, 0x11111111
    s_mov_b32 s63, s62
    s_mul_i32 s21, s4, 5
    s_add_u32 s21, s21, s3
    s_mul_i32 s19, s5, 81920
    s_lshl_b32 s66, s21, 7
    s_add_u32 s19, s19, 528384
    s_add_u32 s66, s66, s19
    s_add_u32 s67, s66, 20480
    s_add_u32 s68, s66, 40960
    s_add_u32 s69, s66, 61440
    v_lshrrev_b32 v45, 3, v0
    v_mul_u32_u24 v45, 2560, v45
    v_and_b32 v11, 0x70, v47
    v_add_u32 v45, v45, v11
    s_lshl_b32 s53, s21, 6
    s_mul_i32 s21, s5, 1280
    s_add_u32 s53, s53, s21
    v_and_b32 v44, 7, v0
    v_lshlrev_b32 v44, 3, v44
    v_lshrrev_b32 v11, 5, v0
    v_lshl_add_u32 v44, v11, 2, v44
    s_cmp_lt_u32 s3, 5
    s_cselect_b32 s52, 1, 0
    s_cmp_lt_u32 s4, 4
    s_cselect_b32 s52, s52, 0
    v_and_b32_dpp v80, v34, v5 row_newbcast:8 row_mask:0xf bank_mask:0xf
    v_and_b32_dpp v81, v34, v6 row_newbcast:8 row_mask:0xf bank_mask:0xf
    v_and_b32_dpp v82, v34, v7 row_newbcast:8 row_mask:0xf bank_mask:0xf
    v_and_b32_dpp v83, v34, v8 row_newbcast:8 row_mask:0xf bank_mask:0xf
    v_and_b32_dpp v168, v34, v5 row_newbcast:12 row_mask:0xf bank_mask:0xf
    v_and_b32_dpp v169, v34, v6 row_newbcast:12 row_mask:0xf bank_mask:0xf
    v_and_b32_dpp v170, v34, v7 row_newbcast:12 row_mask:0xf bank_mask:0xf
    v_and_b32_dpp v171, v34, v8 row_newbcast:12 row_mask:0xf bank_mask:0xf
    v_and_b32_dpp v172, v35, v5 row_newbcast:0 row_mask:0xf bank_mask:0xf
    v_and_b32_dpp v173, v35, v6 row_newbcast:0 row_mask:0xf bank_mask:0xf
    v_and_b32_dpp v174, v35, v7 row_newbcast:0 row_mask:0xf bank_mask:0xf
    v_and_b32_dpp v175, v35, v8 row_newbcast:0 row_mask:0xf bank_mask:0xf
    v_and_b32_dpp v132, v35, v5 row_newbcast:4 row_mask:0xf bank_mask:0xf
    v_and_b32_dpp v133, v35, v6 row_newbcast:4 row_mask:0xf bank_mask:0xf
    v_and_b32_dpp v134, v35, v7 row_newbcast:4 row_mask:0xf bank_mask:0xf
    v_and_b32_dpp v135, v35, v8 row_newbcast:4 row_mask:0xf bank_mask:0xf
    v_and_b32_dpp v136, v35, v5 row_newbcast:8 row_mask:0xf bank_mask:0xf
    v_and_b32_dpp v137, v35, v6 row_newbcast:8 row_mask:0xf bank_mask:0xf
    v_and_b32_dpp v138, v35, v7 row_newbcast:8 row_mask:0xf bank_mask:0xf
    v_and_b32_dpp v139, v35, v8 row_newbcast:8 row_mask:0xf bank_mask:0xf
    v_and_b32_dpp v140, v35, v5 row_newbcast:12 row_mask:0xf bank_mask:0xf
    v_and_b32_dpp v141, v35, v6 row_newbcast:12 row_mask:0xf bank_mask:0xf
    v_and_b32_dpp v142, v35, v7 row_newbcast:12 row_mask:0xf bank_mask:0xf
    v_and_b32_dpp v143, v35, v8 row_newbcast:12 row_mask:0xf bank_mask:0xf
    v_and_b32_dpp v12, v34, v5 row_newbcast:4 row_mask:0xf bank_mask:0xf
    v_and_b32_dpp v13, v34, v6 row_newbcast:4 row_mask:0xf bank_mask:0xf
    v_and_b32_dpp v14, v34, v7 row_newbcast:4 row_mask:0xf bank_mask:0xf
    v_and_b32_dpp v15, v34, v8 row_newbcast:4 row_mask:0xf bank_mask:0xf
    s_waitcnt vmcnt(6)
    s_nop 0
    v_mfma_f32_16x16x32_bf16 v[20:23], v[12:15], v[92:95], v[20:23]
    s_waitcnt vmcnt(5)
    v_mfma_f32_16x16x32_bf16 v[20:23], v[80:83], v[96:99], v[20:23]
    s_waitcnt vmcnt(4)
    v_mfma_f32_16x16x32_bf16 v[20:23], v[168:171], v[88:91], v[20:23]
    s_waitcnt vmcnt(3)
    v_mfma_f32_16x16x32_bf16 v[20:23], v[172:175], v[72:75], v[20:23]
    s_waitcnt vmcnt(2)
    v_mfma_f32_16x16x32_bf16 v[20:23], v[132:135], v[84:87], v[20:23]
    s_waitcnt vmcnt(1)
    v_mfma_f32_16x16x32_bf16 v[20:23], v[136:139], v[236:239], v[20:23]
    s_waitcnt vmcnt(0)
    v_mfma_f32_16x16x32_bf16 v[20:23], v[140:143], v[248:251], v[20:23]
    s_nop 7
    v_mul_f32 v20, s42, v20
    v_mul_f32 v21, s42, v21
    v_mul_f32 v22, s42, v22
    v_mul_f32 v23, s42, v23
    v_cvt_pk_bf16_f32 v20, v20, v21
    v_cvt_pk_bf16_f32 v21, v22, v23
    s_mov_b32 exec_hi, 0
    ds_write2_b32 v9, v20, v21 offset0:0 offset1:32
    s_mov_b64 exec, -1
    s_waitcnt lgkmcnt(0)
    s_barrier
    ds_read_b128 v[184:187], v10 offset:1024
    ds_read_b128 v[48:51], v10 offset:1088
    s_waitcnt lgkmcnt(1)
    v_smfmac_f32_16x16x64_bf16 v[152:155], v[184:187], v[100:107], v39
    s_waitcnt lgkmcnt(0)
    v_smfmac_f32_16x16x64_bf16 v[152:155], v[48:51], v[108:115], v39
    ds_read_b64_tr_b16 v[68:69], v41 offset:0
    ds_read_b64_tr_b16 v[70:71], v41 offset:1024
    ds_read_b64_tr_b16 v[72:73], v41 offset:8192
    ds_read_b64_tr_b16 v[74:75], v41 offset:9216
    ds_read_b64_tr_b16 v[216:217], v41 offset:16384
    ds_read_b64_tr_b16 v[218:219], v41 offset:17408
    ds_read_b64_tr_b16 v[220:221], v41 offset:24576
    ds_read_b64_tr_b16 v[222:223], v41 offset:25600
    v_smfmac_f32_16x16x64_bf16 v[212:215], v[184:187], v[116:123], v39
    v_smfmac_f32_16x16x64_bf16 v[212:215], v[48:51], v[156:163], v39
    v_smfmac_f32_16x16x64_bf16 v[224:227], v[184:187], v[192:199], v39
    v_pk_add_f32 v[152:153], v[152:153], v[154:155]
    v_add_f32 v152, v152, v153
    v_smfmac_f32_16x16x64_bf16 v[224:227], v[48:51], v[124:131], v39
    v_mov_b32 v153, v152
    v_smfmac_f32_16x16x64_bf16 v[164:167], v[184:187], v[144:151], v39
    v_smfmac_f32_16x16x64_bf16 v[164:167], v[48:51], v[204:211], v39
    s_waitcnt lgkmcnt(4)
    v_smfmac_f32_16x16x64_bf16 v[176:179], v[184:187], v[68:75], v39
    s_waitcnt lgkmcnt(0)
    v_smfmac_f32_16x16x64_bf16 v[176:179], v[48:51], v[216:223], v39
    v_permlane32_swap_b32 v152, v153
    v_pk_add_f32 v[212:213], v[212:213], v[214:215]
    v_add_f32 v212, v212, v213
    v_add_f32 v152, v152, v153
    v_pk_add_f32 v[224:225], v[224:225], v[226:227]
    v_add_f32 v224, v224, v225
    v_mov_b32 v153, v152
    v_pk_add_f32 v[164:165], v[164:165], v[166:167]
    v_pk_add_f32 v[176:177], v[176:177], v[178:179]
    v_permlane32_swap_b32 v212, v224
    v_add_f32 v164, v164, v165
    v_add_f32 v176, v176, v177
    v_permlane16_swap_b32 v152, v153
    v_add_f32 v212, v212, v224
    v_permlane32_swap_b32 v164, v176
    v_add_f32 v164, v164, v176
    v_add_f32 v152, v152, v153
    v_bfi_b32 v152, v46, v43, v152
    v_permlane16_swap_b32 v212, v164
    v_add_f32 v212, v212, v164
    v_bfi_b32 v212, v46, v43, v212
    v_mov_b32_dpp v153, v152 quad_perm:[1,1,1,1] row_mask:0xf bank_mask:0xf
    v_mov_b32_dpp v154, v152 quad_perm:[2,2,2,2] row_mask:0xf bank_mask:0xf
    v_mov_b32_dpp v155, v152 quad_perm:[3,3,3,3] row_mask:0xf bank_mask:0xf
    v_mov_b32_dpp v213, v212 quad_perm:[1,1,1,1] row_mask:0xf bank_mask:0xf
    v_mov_b32_dpp v214, v212 quad_perm:[2,2,2,2] row_mask:0xf bank_mask:0xf
    v_mov_b32_dpp v215, v212 quad_perm:[3,3,3,3] row_mask:0xf bank_mask:0xf
    s_mov_b64 exec, s[62:63]
    buffer_store_dwordx4 v[212:215], v42, s[84:87], s18 offen offset:512 sc1
    s_mov_b64 exec, 0x1111
    buffer_store_dwordx4 v[152:155], v42, s[84:87], s18 offen sc1
    s_mov_b64 exec, -1
    s_cmp_eq_u32 s52, 0
    s_cbranch_scc1 L_end
    buffer_load_dwordx4 v[184:187], v45, s[84:87], s66 offen sc1
    buffer_load_dwordx4 v[48:51], v45, s[84:87], s67 offen sc1
    buffer_load_dwordx4 v[52:55], v45, s[84:87], s68 offen sc1
    buffer_load_dwordx4 v[56:59], v45, s[84:87], s69 offen sc1
    s_mov_b32 s20, 2000000
L_poll:
    s_waitcnt vmcnt(0)
L_poll2:
    v_xor_b32 v60, s88, v184
    v_xor_b32 v61, s89, v185
    v_xor_b32 v62, s90, v186
    v_xor_b32 v63, s91, v187
    v_or3_b32 v9, v60, v61, v62
    v_bitop3_b32 v9, v9, v63, v46 bitop3:0xa8
    v_cmp_ne_u32 s[44:45], 0, v9
    v_xor_b32 v64, s88, v48
    v_xor_b32 v65, s89, v49
    v_xor_b32 v66, s90, v50
    v_xor_b32 v67, s91, v51
    v_or3_b32 v9, v64, v65, v66
    v_bitop3_b32 v9, v9, v67, v46 bitop3:0xa8
    v_cmp_ne_u32 s[46:47], 0, v9
    v_xor_b32 v152, s88, v52
    v_xor_b32 v153, s89, v53
    v_xor_b32 v154, s90, v54
    v_xor_b32 v155, s91, v55
    v_or3_b32 v9, v152, v153, v154
    v_bitop3_b32 v9, v9, v155, v46 bitop3:0xa8
    v_cmp_ne_u32 s[48:49], 0, v9
    v_xor_b32 v212, s88, v56
    v_xor_b32 v213, s89, v57
    v_xor_b32 v214, s90, v58
    v_xor_b32 v215, s91, v59
    v_or3_b32 v9, v212, v213, v214
    v_bitop3_b32 v9, v9, v215, v46 bitop3:0xa8
    v_cmp_ne_u32 s[50:51], 0, v9
    v_pk_add_f32 v[60:61], v[60:61], v[64:65]
    v_pk_add_f32 v[62:63], v[62:63], v[66:67]
    v_pk_add_f32 v[152:153], v[152:153], v[212:213]
    v_pk_add_f32 v[154:155], v[154:155], v[214:215]
    v_pk_add_f32 v[60:61], v[60:61], v[152:153]
    v_pk_add_f32 v[62:63], v[62:63], v[154:155]
    s_or_b64 s[54:55], s[44:45], s[46:47]
    s_or_b64 s[56:57], s[48:49], s[50:51]
    s_or_b64 s[54:55], s[54:55], s[56:57]
    s_cbranch_scc0 L_fin
    s_mov_b64 exec, s[44:45]
    buffer_load_dwordx4 v[184:187], v45, s[84:87], s66 offen sc1
    s_mov_b64 exec, s[46:47]
    buffer_load_dwordx4 v[48:51], v45, s[84:87], s67 offen sc1
    s_mov_b64 exec, s[48:49]
    buffer_load_dwordx4 v[52:55], v45, s[84:87], s68 offen sc1
    s_mov_b64 exec, s[50:51]
    buffer_load_dwordx4 v[56:59], v45, s[84:87], s69 offen sc1
    s_mov_b64 exec, -1
    s_sub_u32 s20, s20, 1
    s_cbranch_scc1 L_fin
    s_bcnt1_i32_b64 s54, s[44:45]
    s_bcnt1_i32_b64 s55, s[46:47]
    s_bcnt1_i32_b64 s56, s[48:49]
    s_bcnt1_i32_b64 s57, s[50:51]
    s_add_u32 s54, s54, s55
    s_add_u32 s56, s56, s57
    s_add_u32 s54, s54, s56
    s_cmp_gt_u32 s54, 32
    s_cbranch_scc1 L_poll
    s_waitcnt vmcnt(8)
    s_branch L_poll2
L_fin:
    v_permlane32_swap_b32 v60, v62
    v_permlane32_swap_b32 v61, v63
    v_add_f32 v60, v60, v62
    v_add_f32 v61, v61, v63
    v_mov_b32 v62, v60
    v_mov_b32 v63, v61
    s_nop 0
    v_permlane16_swap_b32 v60, v62
    v_permlane16_swap_b32 v61, v63
    v_add_f32 v60, v60, v62
    v_add_f32 v61, v61, v63
    s_nop 0
    v_add_f32_dpp v60, v60, v60 row_ror:8 row_mask:0xf bank_mask:0xf
    v_add_f32_dpp v61, v61, v61 row_ror:8 row_mask:0xf bank_mask:0xf
    v_cvt_pk_bf16_f32 v60, v60, v61
    s_mov_b32 exec_lo, 0xff
    s_mov_b32 exec_hi, 0xff
    buffer_store_dword v60, v44, s[80:83], s53 offen sc0 sc1
    s_or_b32 s20, s6, s3
    s_cbranch_scc1 L_noep
    v_mov_b32 v9, s92
    s_mov_b64 exec, 1
    buffer_store_dword v9, off, s[84:87], 0 offset:0 sc0 sc1
L_noep:
L_end:
    s_endpgm
.section .rodata,"a"
.p2align 6
.amdhsa_kernel gated_mix__sliding_block_cached__glu_gated_swiglu__decode_kernel
  .amdhsa_next_free_vgpr 256
  .amdhsa_next_free_sgpr 102
  .amdhsa_accum_offset 256
  .amdhsa_group_segment_fixed_size 0
  .amdhsa_kernarg_size 104
  .amdhsa_user_sgpr_count 2
  .amdhsa_user_sgpr_kernarg_segment_ptr 1
  .amdhsa_system_sgpr_workgroup_id_x 1
  .amdhsa_float_denorm_mode_32 3
.end_amdhsa_kernel
```
